```python
import torch

def _softmax(x, axis=-1):
    return torch.softmax(x, dim=axis)
def _gelu(x):
    return torch.nn.functional.gelu(x, approximate="tanh")
def _silu(x):
    return torch.nn.functional.silu(x)
def _sigmoid(x):
    return torch.sigmoid(x)
def _layernorm(x, axis=-1, eps=1e-5):
    m = x.mean(dim=axis, keepdim=True)
    v = x.var(dim=axis, keepdim=True, unbiased=False)
    return (x - m) / torch.sqrt(v + eps)
def _scatter_add(tgt, idx, src, axis=0):
    return tgt.clone().index_add_(axis, idx, src)
def _segment_sum(src, seg, n):
    out = torch.zeros((n,) + src.shape[1:], dtype=src.dtype)
    return out.index_add_(0, seg, src)
def _pad(x, pw):
    flat = tuple(v for pair in reversed(pw) for v in pair)
    return torch.nn.functional.pad(x, flat)

kernel_name = 'standalone__molecular_angular_gemnet__graph'

def setup_inputs():

    _w = (lambda a: (lambda t: t.to(torch.bfloat16) if t.is_floating_point() else t)(torch.as_tensor(a)))
    N, deg, De, L = 50000, 16, 4, 2
    E = N * deg
    T = E * deg
    NR = 8
    dist = torch.rand(E).to(float)
    angle = (torch.rand(T) * torch.pi).to(float)
    centers = torch.linspace(0.0, 1.0, NR).to(float)
    ang_freq = torch.arange(1, L + 1).to(float)
    return {
        "m": _w((lambda *s: torch.randn(*s, dtype=torch.bfloat16) * 0.05)(E, De)),
        "idx_in": _w((lambda lo, hi, *s: torch.randint(lo, hi, s))(0, E, T).to(torch.int64)),
        "idx_out": _w((lambda lo, hi, *s: torch.randint(lo, hi, s))(0, E, T).to(torch.int64)),
        "dist": _w(dist),
        "angle": _w(angle),
        "centers": _w(centers),
        "ang_freq": _w(ang_freq),
        "w_rbf": _w((lambda *s: torch.randn(*s, dtype=torch.bfloat16) * 0.2)(NR, De)),
        "w_sbf": _w((lambda *s: torch.randn(*s, dtype=torch.bfloat16) * 0.2)(NR * L, De)),
        "w_down": _w((lambda *s: torch.randn(*s, dtype=torch.bfloat16) * 0.2)(De, De)),
        "w_up": _w((lambda *s: torch.randn(*s, dtype=torch.bfloat16) * 0.2)(De, De)),
    }

def reference(m, idx_in, idx_out, dist, angle, centers, ang_freq, w_rbf, w_sbf, w_down, w_up):
    E, De = m.shape[0], m.shape[1]
    NR = centers.shape[0]
    L = ang_freq.shape[0]
    rbf = torch.exp(-10.0 * (dist[:, None] - centers[None, :]) ** 2)
    cbf = torch.cos(ang_freq[None, :] * angle[:, None])
    rbf_t = rbf[idx_out]
    sbf = torch.reshape(rbf_t[:, :, None] * cbf[:, None, :], (-1, NR * L))
    x = (m[idx_in] @ w_down) * (sbf @ w_sbf)
    agg = _segment_sum(x, idx_out, E)
    return m + (agg @ w_up) * (rbf @ w_rbf)
```

```asm
; @launch kernel=gemnet_part_kernel grid=(256,1,1) block=(1024,1,1) lds=162624
; @launch kernel=standalone__molecular_angular_gemnet__graph_kernel grid=(256,1,1) block=(1024,1,1) lds=156992
.amdgcn_target "amdgcn-amd-amdhsa--gfx950"
.text
.globl gemnet_part_kernel
.p2align 8
.type gemnet_part_kernel,@function
gemnet_part_kernel:
    s_cmp_ge_u32 s2, 256
    s_cbranch_scc1 K1_END
    s_load_dwordx2 s[4:5], s[0:1], 8
    s_load_dwordx2 s[8:9], s[0:1], 16
    s_load_dwordx2 s[12:13], s[0:1], 32
    s_load_dwordx2 s[16:17], s[0:1], 104
    s_load_dwordx2 s[20:21], s[0:1], 0
    s_load_dwordx2 s[24:25], s[0:1], 72
    s_mov_b32 s6, 51200000
    s_mov_b32 s7, 0x00020000
    s_mov_b32 s10, 51200000
    s_mov_b32 s11, 0x00020000
    s_mov_b32 s14, 25600000
    s_mov_b32 s15, 0x00020000
    s_mov_b32 s18, 268435456
    s_mov_b32 s19, 0x00020000
    s_mov_b32 s22, 6400000
    s_mov_b32 s23, 0x00020000
    v_lshrrev_b32 v5, 6, v0
    s_nop 0
    v_readfirstlane_b32 s44, v5
    v_mov_b32 v4, 0
    v_mov_b32 v5, 0
    v_lshlrev_b32 v6, 3, v0
    ds_write_b64 v6, v[4:5]
    v_and_b32 v6, 0x78, v6
    ds_write_b64 v6, v[4:5] offset:8192
    v_and_b32 v0, 511, v0
    v_lshlrev_b32 v1, 4, v0
    v_lshlrev_b32 v2, 3, v0
    s_mov_b32 s45, 2748780
    s_mov_b32 s46, 85898
    s_mov_b32 s61, 14317
    s_mov_b32 s47, -3125
    s_mov_b32 s52, 0x80000000
    s_mov_b32 s59, 0xffff0000
    s_mov_b32 s60, 12480
    s_lshr_b32 s51, s44, 3
    s_and_b32 s44, s44, 7
    s_lshl_b32 s48, s51, 8
    s_add_u32 s48, s48, s2
    s_mul_i32 s56, s48, 150272
    s_mul_i32 s57, s48, 4224
    s_add_u32 s57, s57, 77594624
    s_mul_i32 s49, s48, 3125
    s_add_u32 s50, s49, 3125
    s_lshr_b32 s49, s49, 3
    s_lshr_b32 s50, s50, 3
    s_sub_u32 s50, s50, s49
    s_sub_u32 s50, s50, 384
    s_lshl_b32 s54, s49, 8
    s_lshl_b32 s55, s49, 7
    s_cmp_lt_u32 s44, s50
    s_cselect_b32 s58, 0, s52
    s_waitcnt lgkmcnt(0)
    s_barrier
    s_cmp_lg_u32 s51, 0
    s_cbranch_scc1 K1_Q
    s_setprio 3
    v_mov_b32 v3, 1
    s_add_u32 s48, s54, 0
    s_add_u32 s49, s55, 0
    buffer_load_dwordx4 v[8:11], v1, s[4:7], s48 offen nt
    buffer_load_dwordx4 v[12:15], v1, s[8:11], s48 offen nt
    buffer_load_dwordx2 v[106:107], v2, s[12:15], s49 offen nt
    s_add_u32 s48, s54, 8192
    s_add_u32 s49, s55, 4096
    buffer_load_dwordx4 v[16:19], v1, s[4:7], s48 offen nt
    buffer_load_dwordx4 v[20:23], v1, s[8:11], s48 offen nt
    buffer_load_dwordx2 v[108:109], v2, s[12:15], s49 offen nt
    s_add_u32 s48, s54, 16384
    s_add_u32 s49, s55, 8192
    buffer_load_dwordx4 v[24:27], v1, s[4:7], s48 offen nt
    buffer_load_dwordx4 v[28:31], v1, s[8:11], s48 offen nt
    buffer_load_dwordx2 v[110:111], v2, s[12:15], s49 offen nt
    s_add_u32 s48, s54, 24576
    s_add_u32 s49, s55, 12288
    buffer_load_dwordx4 v[32:35], v1, s[4:7], s48 offen nt
    buffer_load_dwordx4 v[36:39], v1, s[8:11], s48 offen nt
    buffer_load_dwordx2 v[112:113], v2, s[12:15], s49 offen nt
    s_add_u32 s48, s54, 32768
    s_add_u32 s49, s55, 16384
    buffer_load_dwordx4 v[40:43], v1, s[4:7], s48 offen nt
    buffer_load_dwordx4 v[44:47], v1, s[8:11], s48 offen nt
    buffer_load_dwordx2 v[114:115], v2, s[12:15], s49 offen nt
    s_waitcnt vmcnt(13)
    v_mul_hi_u32_u24 v116, s45, v12
    v_mul_hi_u32_u24 v120, s46, v8
    v_lshlrev_b32 v12, 1, v12
    v_and_b32 v116, 0x1fc, v116
    v_bfi_b32 v120, 1, v8, v120
    v_mad_i32_i24 v12, v116, s47, v12
    v_lshrrev_b32 v8, 1, v8
    v_lshl_or_b32 v116, v120, 9, v116
    v_lshl_or_b32 v8, v12, 18, v8
    ds_add_u32 v116, v3
    v_mul_hi_u32_u24 v117, s45, v13
    v_mul_hi_u32_u24 v121, s46, v9
    v_lshlrev_b32 v13, 1, v13
    v_and_b32 v117, 0x1fc, v117
    v_bfi_b32 v121, 1, v9, v121
    v_mad_i32_i24 v13, v117, s47, v13
    v_lshrrev_b32 v9, 1, v9
    v_lshl_or_b32 v117, v121, 9, v117
    v_lshl_or_b32 v9, v13, 18, v9
    ds_add_u32 v117, v3
    v_mul_hi_u32_u24 v118, s45, v14
    v_mul_hi_u32_u24 v122, s46, v10
    v_lshlrev_b32 v14, 1, v14
    v_and_b32 v118, 0x1fc, v118
    v_bfi_b32 v122, 1, v10, v122
    v_mad_i32_i24 v14, v118, s47, v14
    v_lshrrev_b32 v10, 1, v10
    v_lshl_or_b32 v118, v122, 9, v118
    v_lshl_or_b32 v10, v14, 18, v10
    ds_add_u32 v118, v3
    v_mul_hi_u32_u24 v119, s45, v15
    v_mul_hi_u32_u24 v123, s46, v11
    v_lshlrev_b32 v15, 1, v15
    v_and_b32 v119, 0x1fc, v119
    v_bfi_b32 v123, 1, v11, v123
    v_mad_i32_i24 v15, v119, s47, v15
    v_lshrrev_b32 v11, 1, v11
    v_lshl_or_b32 v119, v123, 9, v119
    v_lshl_or_b32 v11, v15, 18, v11
    ds_add_u32 v119, v3
    s_waitcnt vmcnt(12)
    v_lshl_or_b32 v12, v106, 16, v116
    v_and_or_b32 v13, v106, s59, v117
    v_lshl_or_b32 v14, v107, 16, v118
    v_and_or_b32 v15, v107, s59, v119
    s_add_u32 s48, s54, 40960
    s_add_u32 s49, s55, 20480
    buffer_load_dwordx4 v[48:51], v1, s[4:7], s48 offen nt
    buffer_load_dwordx4 v[52:55], v1, s[8:11], s48 offen nt
    buffer_load_dwordx2 v[106:107], v2, s[12:15], s49 offen nt
    s_waitcnt vmcnt(13)
    v_mul_hi_u32_u24 v116, s45, v20
    v_mul_hi_u32_u24 v120, s46, v16
    v_lshlrev_b32 v20, 1, v20
    v_and_b32 v116, 0x1fc, v116
    v_bfi_b32 v120, 1, v16, v120
    v_mad_i32_i24 v20, v116, s47, v20
    v_lshrrev_b32 v16, 1, v16
    v_lshl_or_b32 v116, v120, 9, v116
    v_lshl_or_b32 v16, v20, 18, v16
    ds_add_u32 v116, v3
    v_mul_hi_u32_u24 v117, s45, v21
    v_mul_hi_u32_u24 v121, s46, v17
    v_lshlrev_b32 v21, 1, v21
    v_and_b32 v117, 0x1fc, v117
    v_bfi_b32 v121, 1, v17, v121
    v_mad_i32_i24 v21, v117, s47, v21
    v_lshrrev_b32 v17, 1, v17
    v_lshl_or_b32 v117, v121, 9, v117
    v_lshl_or_b32 v17, v21, 18, v17
    ds_add_u32 v117, v3
    v_mul_hi_u32_u24 v118, s45, v22
    v_mul_hi_u32_u24 v122, s46, v18
    v_lshlrev_b32 v22, 1, v22
    v_and_b32 v118, 0x1fc, v118
    v_bfi_b32 v122, 1, v18, v122
    v_mad_i32_i24 v22, v118, s47, v22
    v_lshrrev_b32 v18, 1, v18
    v_lshl_or_b32 v118, v122, 9, v118
    v_lshl_or_b32 v18, v22, 18, v18
    ds_add_u32 v118, v3
    v_mul_hi_u32_u24 v119, s45, v23
    v_mul_hi_u32_u24 v123, s46, v19
    v_lshlrev_b32 v23, 1, v23
    v_and_b32 v119, 0x1fc, v119
    v_bfi_b32 v123, 1, v19, v123
    v_mad_i32_i24 v23, v119, s47, v23
    v_lshrrev_b32 v19, 1, v19
    v_lshl_or_b32 v119, v123, 9, v119
    v_lshl_or_b32 v19, v23, 18, v19
    ds_add_u32 v119, v3
    s_waitcnt vmcnt(12)
    v_lshl_or_b32 v20, v108, 16, v116
    v_and_or_b32 v21, v108, s59, v117
    v_lshl_or_b32 v22, v109, 16, v118
    v_and_or_b32 v23, v109, s59, v119
    s_add_u32 s48, s54, 49152
    s_add_u32 s49, s55, 24576
    buffer_load_dwordx4 v[56:59], v1, s[4:7], s48 offen nt
    buffer_load_dwordx4 v[60:63], v1, s[8:11], s48 offen nt
    buffer_load_dwordx2 v[108:109], v2, s[12:15], s49 offen nt
    s_waitcnt vmcnt(13)
    v_mul_hi_u32_u24 v116, s45, v28
    v_mul_hi_u32_u24 v120, s46, v24
    v_lshlrev_b32 v28, 1, v28
    v_and_b32 v116, 0x1fc, v116
    v_bfi_b32 v120, 1, v24, v120
    v_mad_i32_i24 v28, v116, s47, v28
    v_lshrrev_b32 v24, 1, v24
    v_lshl_or_b32 v116, v120, 9, v116
    v_lshl_or_b32 v24, v28, 18, v24
    ds_add_u32 v116, v3
    v_mul_hi_u32_u24 v117, s45, v29
    v_mul_hi_u32_u24 v121, s46, v25
    v_lshlrev_b32 v29, 1, v29
    v_and_b32 v117, 0x1fc, v117
    v_bfi_b32 v121, 1, v25, v121
    v_mad_i32_i24 v29, v117, s47, v29
    v_lshrrev_b32 v25, 1, v25
    v_lshl_or_b32 v117, v121, 9, v117
    v_lshl_or_b32 v25, v29, 18, v25
    ds_add_u32 v117, v3
    v_mul_hi_u32_u24 v118, s45, v30
    v_mul_hi_u32_u24 v122, s46, v26
    v_lshlrev_b32 v30, 1, v30
    v_and_b32 v118, 0x1fc, v118
    v_bfi_b32 v122, 1, v26, v122
    v_mad_i32_i24 v30, v118, s47, v30
    v_lshrrev_b32 v26, 1, v26
    v_lshl_or_b32 v118, v122, 9, v118
    v_lshl_or_b32 v26, v30, 18, v26
    ds_add_u32 v118, v3
    v_mul_hi_u32_u24 v119, s45, v31
    v_mul_hi_u32_u24 v123, s46, v27
    v_lshlrev_b32 v31, 1, v31
    v_and_b32 v119, 0x1fc, v119
    v_bfi_b32 v123, 1, v27, v123
    v_mad_i32_i24 v31, v119, s47, v31
    v_lshrrev_b32 v27, 1, v27
    v_lshl_or_b32 v119, v123, 9, v119
    v_lshl_or_b32 v27, v31, 18, v27
    ds_add_u32 v119, v3
    s_waitcnt vmcnt(12)
    v_lshl_or_b32 v28, v110, 16, v116
    v_and_or_b32 v29, v110, s59, v117
    v_lshl_or_b32 v30, v111, 16, v118
    v_and_or_b32 v31, v111, s59, v119
    s_add_u32 s48, s54, 57344
    s_add_u32 s49, s55, 28672
    buffer_load_dwordx4 v[64:67], v1, s[4:7], s48 offen nt
    buffer_load_dwordx4 v[68:71], v1, s[8:11], s48 offen nt
    buffer_load_dwordx2 v[110:111], v2, s[12:15], s49 offen nt
    s_waitcnt vmcnt(13)
    v_mul_hi_u32_u24 v116, s45, v36
    v_mul_hi_u32_u24 v120, s46, v32
    v_lshlrev_b32 v36, 1, v36
    v_and_b32 v116, 0x1fc, v116
    v_bfi_b32 v120, 1, v32, v120
    v_mad_i32_i24 v36, v116, s47, v36
    v_lshrrev_b32 v32, 1, v32
    v_lshl_or_b32 v116, v120, 9, v116
    v_lshl_or_b32 v32, v36, 18, v32
    ds_add_u32 v116, v3
    v_mul_hi_u32_u24 v117, s45, v37
    v_mul_hi_u32_u24 v121, s46, v33
    v_lshlrev_b32 v37, 1, v37
    v_and_b32 v117, 0x1fc, v117
    v_bfi_b32 v121, 1, v33, v121
    v_mad_i32_i24 v37, v117, s47, v37
    v_lshrrev_b32 v33, 1, v33
    v_lshl_or_b32 v117, v121, 9, v117
    v_lshl_or_b32 v33, v37, 18, v33
    ds_add_u32 v117, v3
    v_mul_hi_u32_u24 v118, s45, v38
    v_mul_hi_u32_u24 v122, s46, v34
    v_lshlrev_b32 v38, 1, v38
    v_and_b32 v118, 0x1fc, v118
    v_bfi_b32 v122, 1, v34, v122
    v_mad_i32_i24 v38, v118, s47, v38
    v_lshrrev_b32 v34, 1, v34
    v_lshl_or_b32 v118, v122, 9, v118
    v_lshl_or_b32 v34, v38, 18, v34
    ds_add_u32 v118, v3
    v_mul_hi_u32_u24 v119, s45, v39
    v_mul_hi_u32_u24 v123, s46, v35
    v_lshlrev_b32 v39, 1, v39
    v_and_b32 v119, 0x1fc, v119
    v_bfi_b32 v123, 1, v35, v123
    v_mad_i32_i24 v39, v119, s47, v39
    v_lshrrev_b32 v35, 1, v35
    v_lshl_or_b32 v119, v123, 9, v119
    v_lshl_or_b32 v35, v39, 18, v35
    ds_add_u32 v119, v3
    s_waitcnt vmcnt(12)
    v_lshl_or_b32 v36, v112, 16, v116
    v_and_or_b32 v37, v112, s59, v117
    v_lshl_or_b32 v38, v113, 16, v118
    v_and_or_b32 v39, v113, s59, v119
    s_add_u32 s48, s54, 65536
    s_add_u32 s49, s55, 32768
    buffer_load_dwordx4 v[72:75], v1, s[4:7], s48 offen nt
    buffer_load_dwordx4 v[76:79], v1, s[8:11], s48 offen nt
    buffer_load_dwordx2 v[112:113], v2, s[12:15], s49 offen nt
    s_waitcnt vmcnt(13)
    v_mul_hi_u32_u24 v116, s45, v44
    v_mul_hi_u32_u24 v120, s46, v40
    v_lshlrev_b32 v44, 1, v44
    v_and_b32 v116, 0x1fc, v116
    v_bfi_b32 v120, 1, v40, v120
    v_mad_i32_i24 v44, v116, s47, v44
    v_lshrrev_b32 v40, 1, v40
    v_lshl_or_b32 v116, v120, 9, v116
    v_lshl_or_b32 v40, v44, 18, v40
    ds_add_u32 v116, v3
    v_mul_hi_u32_u24 v117, s45, v45
    v_mul_hi_u32_u24 v121, s46, v41
    v_lshlrev_b32 v45, 1, v45
    v_and_b32 v117, 0x1fc, v117
    v_bfi_b32 v121, 1, v41, v121
    v_mad_i32_i24 v45, v117, s47, v45
    v_lshrrev_b32 v41, 1, v41
    v_lshl_or_b32 v117, v121, 9, v117
    v_lshl_or_b32 v41, v45, 18, v41
    ds_add_u32 v117, v3
    v_mul_hi_u32_u24 v118, s45, v46
    v_mul_hi_u32_u24 v122, s46, v42
    v_lshlrev_b32 v46, 1, v46
    v_and_b32 v118, 0x1fc, v118
    v_bfi_b32 v122, 1, v42, v122
    v_mad_i32_i24 v46, v118, s47, v46
    v_lshrrev_b32 v42, 1, v42
    v_lshl_or_b32 v118, v122, 9, v118
    v_lshl_or_b32 v42, v46, 18, v42
    ds_add_u32 v118, v3
    v_mul_hi_u32_u24 v119, s45, v47
    v_mul_hi_u32_u24 v123, s46, v43
    v_lshlrev_b32 v47, 1, v47
    v_and_b32 v119, 0x1fc, v119
    v_bfi_b32 v123, 1, v43, v123
    v_mad_i32_i24 v47, v119, s47, v47
    v_lshrrev_b32 v43, 1, v43
    v_lshl_or_b32 v119, v123, 9, v119
    v_lshl_or_b32 v43, v47, 18, v43
    ds_add_u32 v119, v3
    s_waitcnt vmcnt(12)
    v_lshl_or_b32 v44, v114, 16, v116
    v_and_or_b32 v45, v114, s59, v117
    v_lshl_or_b32 v46, v115, 16, v118
    v_and_or_b32 v47, v115, s59, v119
    s_add_u32 s48, s54, 73728
    s_add_u32 s49, s55, 36864
    buffer_load_dwordx4 v[80:83], v1, s[4:7], s48 offen nt
    buffer_load_dwordx4 v[84:87], v1, s[8:11], s48 offen nt
    buffer_load_dwordx2 v[114:115], v2, s[12:15], s49 offen nt
    s_waitcnt vmcnt(13)
    v_mul_hi_u32_u24 v116, s45, v52
    v_mul_hi_u32_u24 v120, s46, v48
    v_lshlrev_b32 v52, 1, v52
    v_and_b32 v116, 0x1fc, v116
    v_bfi_b32 v120, 1, v48, v120
    v_mad_i32_i24 v52, v116, s47, v52
    v_lshrrev_b32 v48, 1, v48
    v_lshl_or_b32 v116, v120, 9, v116
    v_lshl_or_b32 v48, v52, 18, v48
    ds_add_u32 v116, v3
    v_mul_hi_u32_u24 v117, s45, v53
    v_mul_hi_u32_u24 v121, s46, v49
    v_lshlrev_b32 v53, 1, v53
    v_and_b32 v117, 0x1fc, v117
    v_bfi_b32 v121, 1, v49, v121
    v_mad_i32_i24 v53, v117, s47, v53
    v_lshrrev_b32 v49, 1, v49
    v_lshl_or_b32 v117, v121, 9, v117
    v_lshl_or_b32 v49, v53, 18, v49
    ds_add_u32 v117, v3
    v_mul_hi_u32_u24 v118, s45, v54
    v_mul_hi_u32_u24 v122, s46, v50
    v_lshlrev_b32 v54, 1, v54
    v_and_b32 v118, 0x1fc, v118
    v_bfi_b32 v122, 1, v50, v122
    v_mad_i32_i24 v54, v118, s47, v54
    v_lshrrev_b32 v50, 1, v50
    v_lshl_or_b32 v118, v122, 9, v118
    v_lshl_or_b32 v50, v54, 18, v50
    ds_add_u32 v118, v3
    v_mul_hi_u32_u24 v119, s45, v55
    v_mul_hi_u32_u24 v123, s46, v51
    v_lshlrev_b32 v55, 1, v55
    v_and_b32 v119, 0x1fc, v119
    v_bfi_b32 v123, 1, v51, v123
    v_mad_i32_i24 v55, v119, s47, v55
    v_lshrrev_b32 v51, 1, v51
    v_lshl_or_b32 v119, v123, 9, v119
    v_lshl_or_b32 v51, v55, 18, v51
    ds_add_u32 v119, v3
    s_waitcnt vmcnt(12)
    v_lshl_or_b32 v52, v106, 16, v116
    v_and_or_b32 v53, v106, s59, v117
    v_lshl_or_b32 v54, v107, 16, v118
    v_and_or_b32 v55, v107, s59, v119
    s_add_u32 s48, s54, 81920
    s_add_u32 s49, s55, 40960
    buffer_load_dwordx4 v[88:91], v1, s[4:7], s48 offen nt
    buffer_load_dwordx4 v[92:95], v1, s[8:11], s48 offen nt
    buffer_load_dwordx2 v[106:107], v2, s[12:15], s49 offen nt
    s_waitcnt vmcnt(13)
    v_mul_hi_u32_u24 v116, s45, v60
    v_mul_hi_u32_u24 v120, s46, v56
    v_lshlrev_b32 v60, 1, v60
    v_and_b32 v116, 0x1fc, v116
    v_bfi_b32 v120, 1, v56, v120
    v_mad_i32_i24 v60, v116, s47, v60
    v_lshrrev_b32 v56, 1, v56
    v_lshl_or_b32 v116, v120, 9, v116
    v_lshl_or_b32 v56, v60, 18, v56
    ds_add_u32 v116, v3
    v_mul_hi_u32_u24 v117, s45, v61
    v_mul_hi_u32_u24 v121, s46, v57
    v_lshlrev_b32 v61, 1, v61
    v_and_b32 v117, 0x1fc, v117
    v_bfi_b32 v121, 1, v57, v121
    v_mad_i32_i24 v61, v117, s47, v61
    v_lshrrev_b32 v57, 1, v57
    v_lshl_or_b32 v117, v121, 9, v117
    v_lshl_or_b32 v57, v61, 18, v57
    ds_add_u32 v117, v3
    v_mul_hi_u32_u24 v118, s45, v62
    v_mul_hi_u32_u24 v122, s46, v58
    v_lshlrev_b32 v62, 1, v62
    v_and_b32 v118, 0x1fc, v118
    v_bfi_b32 v122, 1, v58, v122
    v_mad_i32_i24 v62, v118, s47, v62
    v_lshrrev_b32 v58, 1, v58
    v_lshl_or_b32 v118, v122, 9, v118
    v_lshl_or_b32 v58, v62, 18, v58
    ds_add_u32 v118, v3
    v_mul_hi_u32_u24 v119, s45, v63
    v_mul_hi_u32_u24 v123, s46, v59
    v_lshlrev_b32 v63, 1, v63
    v_and_b32 v119, 0x1fc, v119
    v_bfi_b32 v123, 1, v59, v123
    v_mad_i32_i24 v63, v119, s47, v63
    v_lshrrev_b32 v59, 1, v59
    v_lshl_or_b32 v119, v123, 9, v119
    v_lshl_or_b32 v59, v63, 18, v59
    ds_add_u32 v119, v3
    s_waitcnt vmcnt(12)
    v_lshl_or_b32 v60, v108, 16, v116
    v_and_or_b32 v61, v108, s59, v117
    v_lshl_or_b32 v62, v109, 16, v118
    v_and_or_b32 v63, v109, s59, v119
    s_add_u32 s48, s54, 90112
    s_add_u32 s49, s55, 45056
    buffer_load_dwordx4 v[96:99], v1, s[4:7], s48 offen nt
    buffer_load_dwordx4 v[100:103], v1, s[8:11], s48 offen nt
    buffer_load_dwordx2 v[108:109], v2, s[12:15], s49 offen nt
    s_waitcnt vmcnt(13)
    v_mul_hi_u32_u24 v116, s45, v68
    v_mul_hi_u32_u24 v120, s46, v64
    v_lshlrev_b32 v68, 1, v68
    v_and_b32 v116, 0x1fc, v116
    v_bfi_b32 v120, 1, v64, v120
    v_mad_i32_i24 v68, v116, s47, v68
    v_lshrrev_b32 v64, 1, v64
    v_lshl_or_b32 v116, v120, 9, v116
    v_lshl_or_b32 v64, v68, 18, v64
    ds_add_u32 v116, v3
    v_mul_hi_u32_u24 v117, s45, v69
    v_mul_hi_u32_u24 v121, s46, v65
    v_lshlrev_b32 v69, 1, v69
    v_and_b32 v117, 0x1fc, v117
    v_bfi_b32 v121, 1, v65, v121
    v_mad_i32_i24 v69, v117, s47, v69
    v_lshrrev_b32 v65, 1, v65
    v_lshl_or_b32 v117, v121, 9, v117
    v_lshl_or_b32 v65, v69, 18, v65
    ds_add_u32 v117, v3
    v_mul_hi_u32_u24 v118, s45, v70
    v_mul_hi_u32_u24 v122, s46, v66
    v_lshlrev_b32 v70, 1, v70
    v_and_b32 v118, 0x1fc, v118
    v_bfi_b32 v122, 1, v66, v122
    v_mad_i32_i24 v70, v118, s47, v70
    v_lshrrev_b32 v66, 1, v66
    v_lshl_or_b32 v118, v122, 9, v118
    v_lshl_or_b32 v66, v70, 18, v66
    ds_add_u32 v118, v3
    v_mul_hi_u32_u24 v119, s45, v71
    v_mul_hi_u32_u24 v123, s46, v67
    v_lshlrev_b32 v71, 1, v71
    v_and_b32 v119, 0x1fc, v119
    v_bfi_b32 v123, 1, v67, v123
    v_mad_i32_i24 v71, v119, s47, v71
    v_lshrrev_b32 v67, 1, v67
    v_lshl_or_b32 v119, v123, 9, v119
    v_lshl_or_b32 v67, v71, 18, v67
    ds_add_u32 v119, v3
    s_waitcnt vmcnt(12)
    v_lshl_or_b32 v68, v110, 16, v116
    v_and_or_b32 v69, v110, s59, v117
    v_lshl_or_b32 v70, v111, 16, v118
    v_and_or_b32 v71, v111, s59, v119
    s_add_u32 s48, s54, 98304
    s_add_u32 s49, s55, 49152
    v_lshl_or_b32 v124, v0, 2, s58
    v_lshl_or_b32 v125, v0, 1, s58
    buffer_load_dword v104, v124, s[4:7], s48 offen nt
    buffer_load_dword v105, v124, s[8:11], s48 offen nt
    buffer_load_ushort v110, v125, s[12:15], s49 offen nt
    s_waitcnt vmcnt(13)
    v_mul_hi_u32_u24 v116, s45, v76
    v_mul_hi_u32_u24 v120, s46, v72
    v_lshlrev_b32 v76, 1, v76
    v_and_b32 v116, 0x1fc, v116
    v_bfi_b32 v120, 1, v72, v120
    v_mad_i32_i24 v76, v116, s47, v76
    v_lshrrev_b32 v72, 1, v72
    v_lshl_or_b32 v116, v120, 9, v116
    v_lshl_or_b32 v72, v76, 18, v72
    ds_add_u32 v116, v3
    v_mul_hi_u32_u24 v117, s45, v77
    v_mul_hi_u32_u24 v121, s46, v73
    v_lshlrev_b32 v77, 1, v77
    v_and_b32 v117, 0x1fc, v117
    v_bfi_b32 v121, 1, v73, v121
    v_mad_i32_i24 v77, v117, s47, v77
    v_lshrrev_b32 v73, 1, v73
    v_lshl_or_b32 v117, v121, 9, v117
    v_lshl_or_b32 v73, v77, 18, v73
    ds_add_u32 v117, v3
    v_mul_hi_u32_u24 v118, s45, v78
    v_mul_hi_u32_u24 v122, s46, v74
    v_lshlrev_b32 v78, 1, v78
    v_and_b32 v118, 0x1fc, v118
    v_bfi_b32 v122, 1, v74, v122
    v_mad_i32_i24 v78, v118, s47, v78
    v_lshrrev_b32 v74, 1, v74
    v_lshl_or_b32 v118, v122, 9, v118
    v_lshl_or_b32 v74, v78, 18, v74
    ds_add_u32 v118, v3
    v_mul_hi_u32_u24 v119, s45, v79
    v_mul_hi_u32_u24 v123, s46, v75
    v_lshlrev_b32 v79, 1, v79
    v_and_b32 v119, 0x1fc, v119
    v_bfi_b32 v123, 1, v75, v123
    v_mad_i32_i24 v79, v119, s47, v79
    v_lshrrev_b32 v75, 1, v75
    v_lshl_or_b32 v119, v123, 9, v119
    v_lshl_or_b32 v75, v79, 18, v75
    ds_add_u32 v119, v3
    s_waitcnt vmcnt(12)
    v_lshl_or_b32 v76, v112, 16, v116
    v_and_or_b32 v77, v112, s59, v117
    v_lshl_or_b32 v78, v113, 16, v118
    v_and_or_b32 v79, v113, s59, v119
    s_waitcnt vmcnt(10)
    v_mul_hi_u32_u24 v116, s45, v84
    v_mul_hi_u32_u24 v120, s46, v80
    v_lshlrev_b32 v84, 1, v84
    v_and_b32 v116, 0x1fc, v116
    v_bfi_b32 v120, 1, v80, v120
    v_mad_i32_i24 v84, v116, s47, v84
    v_lshrrev_b32 v80, 1, v80
    v_lshl_or_b32 v116, v120, 9, v116
    v_lshl_or_b32 v80, v84, 18, v80
    ds_add_u32 v116, v3
    v_mul_hi_u32_u24 v117, s45, v85
    v_mul_hi_u32_u24 v121, s46, v81
    v_lshlrev_b32 v85, 1, v85
    v_and_b32 v117, 0x1fc, v117
    v_bfi_b32 v121, 1, v81, v121
    v_mad_i32_i24 v85, v117, s47, v85
    v_lshrrev_b32 v81, 1, v81
    v_lshl_or_b32 v117, v121, 9, v117
    v_lshl_or_b32 v81, v85, 18, v81
    ds_add_u32 v117, v3
    v_mul_hi_u32_u24 v118, s45, v86
    v_mul_hi_u32_u24 v122, s46, v82
    v_lshlrev_b32 v86, 1, v86
    v_and_b32 v118, 0x1fc, v118
    v_bfi_b32 v122, 1, v82, v122
    v_mad_i32_i24 v86, v118, s47, v86
    v_lshrrev_b32 v82, 1, v82
    v_lshl_or_b32 v118, v122, 9, v118
    v_lshl_or_b32 v82, v86, 18, v82
    ds_add_u32 v118, v3
    v_mul_hi_u32_u24 v119, s45, v87
    v_mul_hi_u32_u24 v123, s46, v83
    v_lshlrev_b32 v87, 1, v87
    v_and_b32 v119, 0x1fc, v119
    v_bfi_b32 v123, 1, v83, v123
    v_mad_i32_i24 v87, v119, s47, v87
    v_lshrrev_b32 v83, 1, v83
    v_lshl_or_b32 v119, v123, 9, v119
    v_lshl_or_b32 v83, v87, 18, v83
    ds_add_u32 v119, v3
    s_waitcnt vmcnt(9)
    v_lshl_or_b32 v84, v114, 16, v116
    v_and_or_b32 v85, v114, s59, v117
    v_lshl_or_b32 v86, v115, 16, v118
    v_and_or_b32 v87, v115, s59, v119
    s_waitcnt vmcnt(7)
    v_mul_hi_u32_u24 v116, s45, v92
    v_mul_hi_u32_u24 v120, s46, v88
    v_lshlrev_b32 v92, 1, v92
    v_and_b32 v116, 0x1fc, v116
    v_bfi_b32 v120, 1, v88, v120
    v_mad_i32_i24 v92, v116, s47, v92
    v_lshrrev_b32 v88, 1, v88
    v_lshl_or_b32 v116, v120, 9, v116
    v_lshl_or_b32 v88, v92, 18, v88
    ds_add_u32 v116, v3
    v_mul_hi_u32_u24 v117, s45, v93
    v_mul_hi_u32_u24 v121, s46, v89
    v_lshlrev_b32 v93, 1, v93
    v_and_b32 v117, 0x1fc, v117
    v_bfi_b32 v121, 1, v89, v121
    v_mad_i32_i24 v93, v117, s47, v93
    v_lshrrev_b32 v89, 1, v89
    v_lshl_or_b32 v117, v121, 9, v117
    v_lshl_or_b32 v89, v93, 18, v89
    ds_add_u32 v117, v3
    v_mul_hi_u32_u24 v118, s45, v94
    v_mul_hi_u32_u24 v122, s46, v90
    v_lshlrev_b32 v94, 1, v94
    v_and_b32 v118, 0x1fc, v118
    v_bfi_b32 v122, 1, v90, v122
    v_mad_i32_i24 v94, v118, s47, v94
    v_lshrrev_b32 v90, 1, v90
    v_lshl_or_b32 v118, v122, 9, v118
    v_lshl_or_b32 v90, v94, 18, v90
    ds_add_u32 v118, v3
    v_mul_hi_u32_u24 v119, s45, v95
    v_mul_hi_u32_u24 v123, s46, v91
    v_lshlrev_b32 v95, 1, v95
    v_and_b32 v119, 0x1fc, v119
    v_bfi_b32 v123, 1, v91, v123
    v_mad_i32_i24 v95, v119, s47, v95
    v_lshrrev_b32 v91, 1, v91
    v_lshl_or_b32 v119, v123, 9, v119
    v_lshl_or_b32 v91, v95, 18, v91
    ds_add_u32 v119, v3
    s_waitcnt vmcnt(6)
    v_lshl_or_b32 v92, v106, 16, v116
    v_and_or_b32 v93, v106, s59, v117
    v_lshl_or_b32 v94, v107, 16, v118
    v_and_or_b32 v95, v107, s59, v119
    s_waitcnt vmcnt(4)
    v_mul_hi_u32_u24 v116, s45, v100
    v_mul_hi_u32_u24 v120, s46, v96
    v_lshlrev_b32 v100, 1, v100
    v_and_b32 v116, 0x1fc, v116
    v_bfi_b32 v120, 1, v96, v120
    v_mad_i32_i24 v100, v116, s47, v100
    v_lshrrev_b32 v96, 1, v96
    v_lshl_or_b32 v116, v120, 9, v116
    v_lshl_or_b32 v96, v100, 18, v96
    ds_add_u32 v116, v3
    v_mul_hi_u32_u24 v117, s45, v101
    v_mul_hi_u32_u24 v121, s46, v97
    v_lshlrev_b32 v101, 1, v101
    v_and_b32 v117, 0x1fc, v117
    v_bfi_b32 v121, 1, v97, v121
    v_mad_i32_i24 v101, v117, s47, v101
    v_lshrrev_b32 v97, 1, v97
    v_lshl_or_b32 v117, v121, 9, v117
    v_lshl_or_b32 v97, v101, 18, v97
    ds_add_u32 v117, v3
    v_mul_hi_u32_u24 v118, s45, v102
    v_mul_hi_u32_u24 v122, s46, v98
    v_lshlrev_b32 v102, 1, v102
    v_and_b32 v118, 0x1fc, v118
    v_bfi_b32 v122, 1, v98, v122
    v_mad_i32_i24 v102, v118, s47, v102
    v_lshrrev_b32 v98, 1, v98
    v_lshl_or_b32 v118, v122, 9, v118
    v_lshl_or_b32 v98, v102, 18, v98
    ds_add_u32 v118, v3
    v_mul_hi_u32_u24 v119, s45, v103
    v_mul_hi_u32_u24 v123, s46, v99
    v_lshlrev_b32 v103, 1, v103
    v_and_b32 v119, 0x1fc, v119
    v_bfi_b32 v123, 1, v99, v123
    v_mad_i32_i24 v103, v119, s47, v103
    v_lshrrev_b32 v99, 1, v99
    v_lshl_or_b32 v119, v123, 9, v119
    v_lshl_or_b32 v99, v103, 18, v99
    ds_add_u32 v119, v3
    s_waitcnt vmcnt(3)
    v_lshl_or_b32 v100, v108, 16, v116
    v_and_or_b32 v101, v108, s59, v117
    v_lshl_or_b32 v102, v109, 16, v118
    v_and_or_b32 v103, v109, s59, v119
    s_waitcnt vmcnt(1)
    s_cmp_eq_u32 s58, 0
    s_cselect_b64 exec, -1, 0
    v_mul_hi_u32_u24 v116, s45, v105
    v_mul_hi_u32_u24 v120, s46, v104
    v_lshlrev_b32 v105, 1, v105
    v_and_b32 v116, 0x1fc, v116
    v_bfi_b32 v120, 1, v104, v120
    v_mad_i32_i24 v105, v116, s47, v105
    v_lshrrev_b32 v104, 1, v104
    v_lshl_or_b32 v116, v120, 9, v116
    v_lshl_or_b32 v104, v105, 18, v104
    ds_add_u32 v116, v3
    s_waitcnt vmcnt(0)
    v_lshl_or_b32 v105, v110, 16, v116
    s_mov_b64 exec, -1
    s_mov_b64 exec, 1
    ds_add_u32 v4, v3 offset:8224
    s_mov_b64 exec, -1
K1_PL1:
    ds_read_b32 v7, v4 offset:8224
    s_waitcnt lgkmcnt(0)
    v_readfirstlane_b32 s48, v7
    s_cmp_lt_u32 s48, 8
    s_cbranch_scc1 K1_PL1
    ds_read_b128 v[108:111], v1
    s_waitcnt lgkmcnt(0)
    v_and_b32 v108, 0xffff, v108
    v_and_b32 v109, 0xffff, v109
    v_and_b32 v110, 0xffff, v110
    v_and_b32 v111, 0xffff, v111
    v_add_u32 v112, v108, v109
    v_add3_u32 v112, v112, v110, v111
    v_mov_b32 v113, v112
    s_nop 0
    v_add_u32_dpp v112, v112, v112 row_shr:1 row_mask:0xf bank_mask:0xf bound_ctrl:0
    s_nop 1
    v_add_u32_dpp v112, v112, v112 row_shr:2 row_mask:0xf bank_mask:0xf bound_ctrl:0
    s_nop 1
    v_add_u32_dpp v112, v112, v112 row_shr:4 row_mask:0xf bank_mask:0xf bound_ctrl:0
    s_nop 1
    v_add_u32_dpp v112, v112, v112 row_shr:8 row_mask:0xf bank_mask:0xf bound_ctrl:0
    s_nop 1
    v_add_u32_dpp v112, v112, v112 row_bcast:15 row_mask:0xa bank_mask:0xf
    s_nop 1
    v_add_u32_dpp v112, v112, v112 row_bcast:31 row_mask:0xc bank_mask:0xf
    s_lshl_b32 s48, s44, 2
    v_mov_b32 v116, s48
    s_lshl_b64 exec, 1, 63
    ds_write_b32 v116, v112 offset:8192
    s_mov_b64 exec, -1
    v_sub_u32 v112, v112, v113
    v_and_b32 v120, 7, v0
    v_lshlrev_b32 v116, 2, v120
    v_and_b32 v122, 63, v0
    s_lshl_b32 s49, s44, 1
    v_lshl_add_u32 v122, v122, 6, s49
    s_mov_b64 exec, 1
    ds_add_u32 v4, v3 offset:8228
    s_mov_b64 exec, -1
K1_PL2:
    ds_read_b32 v7, v4 offset:8228
    s_waitcnt lgkmcnt(0)
    v_readfirstlane_b32 s48, v7
    s_cmp_lt_u32 s48, 8
    s_cbranch_scc1 K1_PL2
    ds_read_b32 v121, v116 offset:8192
    v_cmp_gt_u32 vcc, s44, v120
    s_waitcnt lgkmcnt(0)
    s_nop 0
    v_cndmask_b32 v121, 0, v121, vcc
    s_nop 1
    v_add_u32_dpp v121, v121, v121 row_shr:1 row_mask:0xf bank_mask:0xf bound_ctrl:0
    s_nop 1
    v_add_u32_dpp v121, v121, v121 row_shr:2 row_mask:0xf bank_mask:0xf bound_ctrl:0
    s_nop 1
    v_add_u32_dpp v121, v121, v121 row_shr:4 row_mask:0xf bank_mask:0xf bound_ctrl:0
    s_nop 0
    v_readlane_b32 s51, v121, 7
    s_nop 1
    v_add_u32 v116, s51, v112
    v_add_u32 v117, v116, v108
    v_add_u32 v118, v117, v109
    v_add_u32 v119, v118, v110
    v_add_u32 v120, v119, v111
    v_sub_u32 v108, v116, v108
    v_sub_u32 v109, v117, v109
    v_sub_u32 v110, v118, v110
    v_sub_u32 v111, v119, v111
    ds_add_u32 v1, v108 offset:0
    ds_add_u32 v1, v109 offset:4
    ds_add_u32 v1, v110 offset:8
    ds_add_u32 v1, v111 offset:12
    ds_write_b16 v122, v116 offset:8320
    ds_write_b16 v122, v117 offset:8336
    ds_write_b16 v122, v118 offset:8352
    ds_write_b16 v122, v119 offset:8368
    ds_write_b16 v122, v120 offset:8384
    s_mov_b64 exec, 1
    ds_add_u32 v4, v3 offset:8232
    s_mov_b64 exec, -1
K1_PL3:
    ds_read_b32 v7, v4 offset:8232
    s_waitcnt lgkmcnt(0)
    v_readfirstlane_b32 s48, v7
    s_cmp_lt_u32 s48, 8
    s_cbranch_scc1 K1_PL3
    ds_read_b128 v[120:123], v1 offset:8320
    v_and_b32 v106, 0xffff, v12
    v_and_b32 v107, 0xffff, v13
    v_and_b32 v108, 0xffff, v14
    v_and_b32 v109, 0xffff, v15
    ds_add_rtn_u32 v106, v106, v3
    ds_add_rtn_u32 v107, v107, v3
    ds_add_rtn_u32 v108, v108, v3
    ds_add_rtn_u32 v109, v109, v3
    v_cmp_gt_u32 vcc, 257, v0
    v_mov_b32 v5, s52
    s_nop 0
    v_cndmask_b32 v5, v5, v1, vcc
    s_waitcnt lgkmcnt(4)
    buffer_store_dwordx4 v[120:123], v5, s[16:19], s57 offen sc1
    v_and_b32 v110, 0xffff, v20
    v_and_b32 v111, 0xffff, v21
    v_and_b32 v112, 0xffff, v22
    v_and_b32 v113, 0xffff, v23
    ds_add_rtn_u32 v110, v110, v3
    ds_add_rtn_u32 v111, v111, v3
    ds_add_rtn_u32 v112, v112, v3
    ds_add_rtn_u32 v113, v113, v3
    s_waitcnt lgkmcnt(4)
    v_mad_u32_u16 v106, v106, 6, s60
    v_and_b32 v118, 2, v106
    v_add_u32 v114, v106, v118
    v_mad_i32_i24 v118, v118, -2, v106
    v_mad_u32_u16 v107, v107, 6, s60
    v_and_b32 v119, 2, v107
    v_add_u32 v115, v107, v119
    v_mad_i32_i24 v119, v119, -2, v107
    v_mad_u32_u16 v108, v108, 6, s60
    v_and_b32 v120, 2, v108
    v_add_u32 v116, v108, v120
    v_mad_i32_i24 v120, v120, -2, v108
    v_mad_u32_u16 v109, v109, 6, s60
    v_and_b32 v121, 2, v109
    v_add_u32 v117, v109, v121
    v_mad_i32_i24 v121, v121, -2, v109
    ds_write_b32 v114, v8
    ds_write_b16_d16_hi v118, v12 offset:4
    ds_write_b32 v115, v9
    ds_write_b16_d16_hi v119, v13 offset:4
    ds_write_b32 v116, v10
    ds_write_b16_d16_hi v120, v14 offset:4
    ds_write_b32 v117, v11
    ds_write_b16_d16_hi v121, v15 offset:4
    v_and_b32 v106, 0xffff, v28
    v_and_b32 v107, 0xffff, v29
    v_and_b32 v108, 0xffff, v30
    v_and_b32 v109, 0xffff, v31
    ds_add_rtn_u32 v106, v106, v3
    ds_add_rtn_u32 v107, v107, v3
    ds_add_rtn_u32 v108, v108, v3
    ds_add_rtn_u32 v109, v109, v3
    s_waitcnt lgkmcnt(12)
    v_mad_u32_u16 v110, v110, 6, s60
    v_and_b32 v118, 2, v110
    v_add_u32 v114, v110, v118
    v_mad_i32_i24 v118, v118, -2, v110
    v_mad_u32_u16 v111, v111, 6, s60
    v_and_b32 v119, 2, v111
    v_add_u32 v115, v111, v119
    v_mad_i32_i24 v119, v119, -2, v111
    v_mad_u32_u16 v112, v112, 6, s60
    v_and_b32 v120, 2, v112
    v_add_u32 v116, v112, v120
    v_mad_i32_i24 v120, v120, -2, v112
    v_mad_u32_u16 v113, v113, 6, s60
    v_and_b32 v121, 2, v113
    v_add_u32 v117, v113, v121
    v_mad_i32_i24 v121, v121, -2, v113
    ds_write_b32 v114, v16
    ds_write_b16_d16_hi v118, v20 offset:4
    ds_write_b32 v115, v17
    ds_write_b16_d16_hi v119, v21 offset:4
    ds_write_b32 v116, v18
    ds_write_b16_d16_hi v120, v22 offset:4
    ds_write_b32 v117, v19
    ds_write_b16_d16_hi v121, v23 offset:4
    v_and_b32 v110, 0xffff, v36
    v_and_b32 v111, 0xffff, v37
    v_and_b32 v112, 0xffff, v38
    v_and_b32 v113, 0xffff, v39
    ds_add_rtn_u32 v110, v110, v3
    ds_add_rtn_u32 v111, v111, v3
    ds_add_rtn_u32 v112, v112, v3
    ds_add_rtn_u32 v113, v113, v3
    s_waitcnt lgkmcnt(12)
    v_mad_u32_u16 v106, v106, 6, s60
    v_and_b32 v118, 2, v106
    v_add_u32 v114, v106, v118
    v_mad_i32_i24 v118, v118, -2, v106
    v_mad_u32_u16 v107, v107, 6, s60
    v_and_b32 v119, 2, v107
    v_add_u32 v115, v107, v119
    v_mad_i32_i24 v119, v119, -2, v107
    v_mad_u32_u16 v108, v108, 6, s60
    v_and_b32 v120, 2, v108
    v_add_u32 v116, v108, v120
    v_mad_i32_i24 v120, v120, -2, v108
    v_mad_u32_u16 v109, v109, 6, s60
    v_and_b32 v121, 2, v109
    v_add_u32 v117, v109, v121
    v_mad_i32_i24 v121, v121, -2, v109
    ds_write_b32 v114, v24
    ds_write_b16_d16_hi v118, v28 offset:4
    ds_write_b32 v115, v25
    ds_write_b16_d16_hi v119, v29 offset:4
    ds_write_b32 v116, v26
    ds_write_b16_d16_hi v120, v30 offset:4
    ds_write_b32 v117, v27
    ds_write_b16_d16_hi v121, v31 offset:4
    v_and_b32 v106, 0xffff, v44
    v_and_b32 v107, 0xffff, v45
    v_and_b32 v108, 0xffff, v46
    v_and_b32 v109, 0xffff, v47
    ds_add_rtn_u32 v106, v106, v3
    ds_add_rtn_u32 v107, v107, v3
    ds_add_rtn_u32 v108, v108, v3
    ds_add_rtn_u32 v109, v109, v3
    s_waitcnt lgkmcnt(12)
    v_mad_u32_u16 v110, v110, 6, s60
    v_and_b32 v118, 2, v110
    v_add_u32 v114, v110, v118
    v_mad_i32_i24 v118, v118, -2, v110
    v_mad_u32_u16 v111, v111, 6, s60
    v_and_b32 v119, 2, v111
    v_add_u32 v115, v111, v119
    v_mad_i32_i24 v119, v119, -2, v111
    v_mad_u32_u16 v112, v112, 6, s60
    v_and_b32 v120, 2, v112
    v_add_u32 v116, v112, v120
    v_mad_i32_i24 v120, v120, -2, v112
    v_mad_u32_u16 v113, v113, 6, s60
    v_and_b32 v121, 2, v113
    v_add_u32 v117, v113, v121
    v_mad_i32_i24 v121, v121, -2, v113
    ds_write_b32 v114, v32
    ds_write_b16_d16_hi v118, v36 offset:4
    ds_write_b32 v115, v33
    ds_write_b16_d16_hi v119, v37 offset:4
    ds_write_b32 v116, v34
    ds_write_b16_d16_hi v120, v38 offset:4
    ds_write_b32 v117, v35
    ds_write_b16_d16_hi v121, v39 offset:4
    v_and_b32 v110, 0xffff, v52
    v_and_b32 v111, 0xffff, v53
    v_and_b32 v112, 0xffff, v54
    v_and_b32 v113, 0xffff, v55
    ds_add_rtn_u32 v110, v110, v3
    ds_add_rtn_u32 v111, v111, v3
    ds_add_rtn_u32 v112, v112, v3
    ds_add_rtn_u32 v113, v113, v3
    s_waitcnt lgkmcnt(12)
    v_mad_u32_u16 v106, v106, 6, s60
    v_and_b32 v118, 2, v106
    v_add_u32 v114, v106, v118
    v_mad_i32_i24 v118, v118, -2, v106
    v_mad_u32_u16 v107, v107, 6, s60
    v_and_b32 v119, 2, v107
    v_add_u32 v115, v107, v119
    v_mad_i32_i24 v119, v119, -2, v107
    v_mad_u32_u16 v108, v108, 6, s60
    v_and_b32 v120, 2, v108
    v_add_u32 v116, v108, v120
    v_mad_i32_i24 v120, v120, -2, v108
    v_mad_u32_u16 v109, v109, 6, s60
    v_and_b32 v121, 2, v109
    v_add_u32 v117, v109, v121
    v_mad_i32_i24 v121, v121, -2, v109
    ds_write_b32 v114, v40
    ds_write_b16_d16_hi v118, v44 offset:4
    ds_write_b32 v115, v41
    ds_write_b16_d16_hi v119, v45 offset:4
    ds_write_b32 v116, v42
    ds_write_b16_d16_hi v120, v46 offset:4
    ds_write_b32 v117, v43
    ds_write_b16_d16_hi v121, v47 offset:4
    v_and_b32 v106, 0xffff, v60
    v_and_b32 v107, 0xffff, v61
    v_and_b32 v108, 0xffff, v62
    v_and_b32 v109, 0xffff, v63
    ds_add_rtn_u32 v106, v106, v3
    ds_add_rtn_u32 v107, v107, v3
    ds_add_rtn_u32 v108, v108, v3
    ds_add_rtn_u32 v109, v109, v3
    s_waitcnt lgkmcnt(12)
    v_mad_u32_u16 v110, v110, 6, s60
    v_and_b32 v118, 2, v110
    v_add_u32 v114, v110, v118
    v_mad_i32_i24 v118, v118, -2, v110
    v_mad_u32_u16 v111, v111, 6, s60
    v_and_b32 v119, 2, v111
    v_add_u32 v115, v111, v119
    v_mad_i32_i24 v119, v119, -2, v111
    v_mad_u32_u16 v112, v112, 6, s60
    v_and_b32 v120, 2, v112
    v_add_u32 v116, v112, v120
    v_mad_i32_i24 v120, v120, -2, v112
    v_mad_u32_u16 v113, v113, 6, s60
    v_and_b32 v121, 2, v113
    v_add_u32 v117, v113, v121
    v_mad_i32_i24 v121, v121, -2, v113
    ds_write_b32 v114, v48
    ds_write_b16_d16_hi v118, v52 offset:4
    ds_write_b32 v115, v49
    ds_write_b16_d16_hi v119, v53 offset:4
    ds_write_b32 v116, v50
    ds_write_b16_d16_hi v120, v54 offset:4
    ds_write_b32 v117, v51
    ds_write_b16_d16_hi v121, v55 offset:4
    v_and_b32 v110, 0xffff, v68
    v_and_b32 v111, 0xffff, v69
    v_and_b32 v112, 0xffff, v70
    v_and_b32 v113, 0xffff, v71
    ds_add_rtn_u32 v110, v110, v3
    ds_add_rtn_u32 v111, v111, v3
    ds_add_rtn_u32 v112, v112, v3
    ds_add_rtn_u32 v113, v113, v3
    s_waitcnt lgkmcnt(12)
    v_mad_u32_u16 v106, v106, 6, s60
    v_and_b32 v118, 2, v106
    v_add_u32 v114, v106, v118
    v_mad_i32_i24 v118, v118, -2, v106
    v_mad_u32_u16 v107, v107, 6, s60
    v_and_b32 v119, 2, v107
    v_add_u32 v115, v107, v119
    v_mad_i32_i24 v119, v119, -2, v107
    v_mad_u32_u16 v108, v108, 6, s60
    v_and_b32 v120, 2, v108
    v_add_u32 v116, v108, v120
    v_mad_i32_i24 v120, v120, -2, v108
    v_mad_u32_u16 v109, v109, 6, s60
    v_and_b32 v121, 2, v109
    v_add_u32 v117, v109, v121
    v_mad_i32_i24 v121, v121, -2, v109
    ds_write_b32 v114, v56
    ds_write_b16_d16_hi v118, v60 offset:4
    ds_write_b32 v115, v57
    ds_write_b16_d16_hi v119, v61 offset:4
    ds_write_b32 v116, v58
    ds_write_b16_d16_hi v120, v62 offset:4
    ds_write_b32 v117, v59
    ds_write_b16_d16_hi v121, v63 offset:4
    v_and_b32 v106, 0xffff, v76
    v_and_b32 v107, 0xffff, v77
    v_and_b32 v108, 0xffff, v78
    v_and_b32 v109, 0xffff, v79
    ds_add_rtn_u32 v106, v106, v3
    ds_add_rtn_u32 v107, v107, v3
    ds_add_rtn_u32 v108, v108, v3
    ds_add_rtn_u32 v109, v109, v3
    s_waitcnt lgkmcnt(12)
    v_mad_u32_u16 v110, v110, 6, s60
    v_and_b32 v118, 2, v110
    v_add_u32 v114, v110, v118
    v_mad_i32_i24 v118, v118, -2, v110
    v_mad_u32_u16 v111, v111, 6, s60
    v_and_b32 v119, 2, v111
    v_add_u32 v115, v111, v119
    v_mad_i32_i24 v119, v119, -2, v111
    v_mad_u32_u16 v112, v112, 6, s60
    v_and_b32 v120, 2, v112
    v_add_u32 v116, v112, v120
    v_mad_i32_i24 v120, v120, -2, v112
    v_mad_u32_u16 v113, v113, 6, s60
    v_and_b32 v121, 2, v113
    v_add_u32 v117, v113, v121
    v_mad_i32_i24 v121, v121, -2, v113
    ds_write_b32 v114, v64
    ds_write_b16_d16_hi v118, v68 offset:4
    ds_write_b32 v115, v65
    ds_write_b16_d16_hi v119, v69 offset:4
    ds_write_b32 v116, v66
    ds_write_b16_d16_hi v120, v70 offset:4
    ds_write_b32 v117, v67
    ds_write_b16_d16_hi v121, v71 offset:4
    v_and_b32 v110, 0xffff, v84
    v_and_b32 v111, 0xffff, v85
    v_and_b32 v112, 0xffff, v86
    v_and_b32 v113, 0xffff, v87
    ds_add_rtn_u32 v110, v110, v3
    ds_add_rtn_u32 v111, v111, v3
    ds_add_rtn_u32 v112, v112, v3
    ds_add_rtn_u32 v113, v113, v3
    s_waitcnt lgkmcnt(12)
    v_mad_u32_u16 v106, v106, 6, s60
    v_and_b32 v118, 2, v106
    v_add_u32 v114, v106, v118
    v_mad_i32_i24 v118, v118, -2, v106
    v_mad_u32_u16 v107, v107, 6, s60
    v_and_b32 v119, 2, v107
    v_add_u32 v115, v107, v119
    v_mad_i32_i24 v119, v119, -2, v107
    v_mad_u32_u16 v108, v108, 6, s60
    v_and_b32 v120, 2, v108
    v_add_u32 v116, v108, v120
    v_mad_i32_i24 v120, v120, -2, v108
    v_mad_u32_u16 v109, v109, 6, s60
    v_and_b32 v121, 2, v109
    v_add_u32 v117, v109, v121
    v_mad_i32_i24 v121, v121, -2, v109
    ds_write_b32 v114, v72
    ds_write_b16_d16_hi v118, v76 offset:4
    ds_write_b32 v115, v73
    ds_write_b16_d16_hi v119, v77 offset:4
    ds_write_b32 v116, v74
    ds_write_b16_d16_hi v120, v78 offset:4
    ds_write_b32 v117, v75
    ds_write_b16_d16_hi v121, v79 offset:4
    v_and_b32 v106, 0xffff, v92
    v_and_b32 v107, 0xffff, v93
    v_and_b32 v108, 0xffff, v94
    v_and_b32 v109, 0xffff, v95
    ds_add_rtn_u32 v106, v106, v3
    ds_add_rtn_u32 v107, v107, v3
    ds_add_rtn_u32 v108, v108, v3
    ds_add_rtn_u32 v109, v109, v3
    s_waitcnt lgkmcnt(12)
    v_mad_u32_u16 v110, v110, 6, s60
    v_and_b32 v118, 2, v110
    v_add_u32 v114, v110, v118
    v_mad_i32_i24 v118, v118, -2, v110
    v_mad_u32_u16 v111, v111, 6, s60
    v_and_b32 v119, 2, v111
    v_add_u32 v115, v111, v119
    v_mad_i32_i24 v119, v119, -2, v111
    v_mad_u32_u16 v112, v112, 6, s60
    v_and_b32 v120, 2, v112
    v_add_u32 v116, v112, v120
    v_mad_i32_i24 v120, v120, -2, v112
    v_mad_u32_u16 v113, v113, 6, s60
    v_and_b32 v121, 2, v113
    v_add_u32 v117, v113, v121
    v_mad_i32_i24 v121, v121, -2, v113
    ds_write_b32 v114, v80
    ds_write_b16_d16_hi v118, v84 offset:4
    ds_write_b32 v115, v81
    ds_write_b16_d16_hi v119, v85 offset:4
    ds_write_b32 v116, v82
    ds_write_b16_d16_hi v120, v86 offset:4
    ds_write_b32 v117, v83
    ds_write_b16_d16_hi v121, v87 offset:4
    v_and_b32 v110, 0xffff, v100
    v_and_b32 v111, 0xffff, v101
    v_and_b32 v112, 0xffff, v102
    v_and_b32 v113, 0xffff, v103
    ds_add_rtn_u32 v110, v110, v3
    ds_add_rtn_u32 v111, v111, v3
    ds_add_rtn_u32 v112, v112, v3
    ds_add_rtn_u32 v113, v113, v3
    s_waitcnt lgkmcnt(12)
    v_mad_u32_u16 v106, v106, 6, s60
    v_and_b32 v118, 2, v106
    v_add_u32 v114, v106, v118
    v_mad_i32_i24 v118, v118, -2, v106
    v_mad_u32_u16 v107, v107, 6, s60
    v_and_b32 v119, 2, v107
    v_add_u32 v115, v107, v119
    v_mad_i32_i24 v119, v119, -2, v107
    v_mad_u32_u16 v108, v108, 6, s60
    v_and_b32 v120, 2, v108
    v_add_u32 v116, v108, v120
    v_mad_i32_i24 v120, v120, -2, v108
    v_mad_u32_u16 v109, v109, 6, s60
    v_and_b32 v121, 2, v109
    v_add_u32 v117, v109, v121
    v_mad_i32_i24 v121, v121, -2, v109
    ds_write_b32 v114, v88
    ds_write_b16_d16_hi v118, v92 offset:4
    ds_write_b32 v115, v89
    ds_write_b16_d16_hi v119, v93 offset:4
    ds_write_b32 v116, v90
    ds_write_b16_d16_hi v120, v94 offset:4
    ds_write_b32 v117, v91
    ds_write_b16_d16_hi v121, v95 offset:4
    v_and_b32 v106, 0xffff, v105
    s_cmp_eq_u32 s58, 0
    s_cselect_b64 exec, -1, 0
    ds_add_rtn_u32 v106, v106, v3
    s_mov_b64 exec, -1
    s_waitcnt lgkmcnt(9)
    v_mad_u32_u16 v110, v110, 6, s60
    v_and_b32 v118, 2, v110
    v_add_u32 v114, v110, v118
    v_mad_i32_i24 v118, v118, -2, v110
    v_mad_u32_u16 v111, v111, 6, s60
    v_and_b32 v119, 2, v111
    v_add_u32 v115, v111, v119
    v_mad_i32_i24 v119, v119, -2, v111
    v_mad_u32_u16 v112, v112, 6, s60
    v_and_b32 v120, 2, v112
    v_add_u32 v116, v112, v120
    v_mad_i32_i24 v120, v120, -2, v112
    v_mad_u32_u16 v113, v113, 6, s60
    v_and_b32 v121, 2, v113
    v_add_u32 v117, v113, v121
    v_mad_i32_i24 v121, v121, -2, v113
    ds_write_b32 v114, v96
    ds_write_b16_d16_hi v118, v100 offset:4
    ds_write_b32 v115, v97
    ds_write_b16_d16_hi v119, v101 offset:4
    ds_write_b32 v116, v98
    ds_write_b16_d16_hi v120, v102 offset:4
    ds_write_b32 v117, v99
    ds_write_b16_d16_hi v121, v103 offset:4
    s_waitcnt lgkmcnt(8)
    v_mad_u32_u16 v106, v106, 6, s60
    v_and_b32 v118, 2, v106
    v_add_u32 v114, v106, v118
    v_mad_i32_i24 v118, v118, -2, v106
    s_cmp_eq_u32 s58, 0
    s_cselect_b64 exec, -1, 0
    ds_write_b32 v114, v104
    ds_write_b16_d16_hi v118, v105 offset:4
    s_mov_b64 exec, -1
    s_mov_b64 exec, 1
    ds_add_u32 v4, v3 offset:8236
    s_mov_b64 exec, -1
K1_PL4:
    ds_read_b32 v7, v4 offset:8236
    s_waitcnt lgkmcnt(0)
    v_readfirstlane_b32 s48, v7
    s_cmp_lt_u32 s48, 8
    s_cbranch_scc1 K1_PL4
    v_add_u32 v116, 12480, v1
    v_add_u32 v117, 78016, v1
    v_add_u32 v118, 143552, v1
    v_cmp_gt_u32 vcc, 168, v0
    v_mov_b32 v5, s52
    s_nop 0
    v_cndmask_b32 v5, v5, v1, vcc
    v_cndmask_b32 v6, v116, v118, vcc
    ds_read_b128 v[8:11], v116 offset:0
    ds_read_b128 v[12:15], v116 offset:8192
    ds_read_b128 v[16:19], v116 offset:16384
    ds_read_b128 v[20:23], v116 offset:24576
    ds_read_b128 v[24:27], v116 offset:32768
    ds_read_b128 v[28:31], v116 offset:40960
    ds_read_b128 v[32:35], v116 offset:49152
    ds_read_b128 v[36:39], v116 offset:57344
    ds_read_b128 v[40:43], v117 offset:0
    ds_read_b128 v[44:47], v117 offset:8192
    ds_read_b128 v[48:51], v117 offset:16384
    ds_read_b128 v[52:55], v117 offset:24576
    ds_read_b128 v[56:59], v117 offset:32768
    ds_read_b128 v[60:63], v117 offset:40960
    ds_read_b128 v[64:67], v117 offset:49152
    ds_read_b128 v[68:71], v117 offset:57344
    ds_read_b128 v[72:75], v118 offset:0
    ds_read_b128 v[76:79], v118 offset:8192
    ds_read_b128 v[80:83], v6 offset:16384
    s_waitcnt lgkmcnt(14)
    s_add_u32 s50, s56, 0
    buffer_store_dwordx4 v[8:11], v1, s[16:19], s50 offen sc1
    s_add_u32 s50, s56, 8192
    buffer_store_dwordx4 v[12:15], v1, s[16:19], s50 offen sc1
    s_add_u32 s50, s56, 16384
    buffer_store_dwordx4 v[16:19], v1, s[16:19], s50 offen sc1
    s_add_u32 s50, s56, 24576
    buffer_store_dwordx4 v[20:23], v1, s[16:19], s50 offen sc1
    s_add_u32 s50, s56, 32768
    buffer_store_dwordx4 v[24:27], v1, s[16:19], s50 offen sc1
    s_waitcnt lgkmcnt(13)
    s_add_u32 s50, s56, 40960
    buffer_store_dwordx4 v[28:31], v1, s[16:19], s50 offen sc1
    s_waitcnt lgkmcnt(12)
    s_add_u32 s50, s56, 49152
    buffer_store_dwordx4 v[32:35], v1, s[16:19], s50 offen sc1
    s_waitcnt lgkmcnt(0)
    s_barrier
    s_add_u32 s50, s56, 57344
    buffer_store_dwordx4 v[36:39], v1, s[16:19], s50 offen sc1
    s_add_u32 s50, s56, 65536
    buffer_store_dwordx4 v[40:43], v1, s[16:19], s50 offen sc1
    s_add_u32 s50, s56, 73728
    buffer_store_dwordx4 v[44:47], v1, s[16:19], s50 offen sc1
    s_add_u32 s50, s56, 81920
    buffer_store_dwordx4 v[48:51], v1, s[16:19], s50 offen sc1
    s_add_u32 s50, s56, 90112
    buffer_store_dwordx4 v[52:55], v1, s[16:19], s50 offen sc1
    s_add_u32 s50, s56, 98304
    buffer_store_dwordx4 v[56:59], v1, s[16:19], s50 offen sc1
    s_add_u32 s50, s56, 106496
    buffer_store_dwordx4 v[60:63], v1, s[16:19], s50 offen sc1
    s_add_u32 s50, s56, 114688
    buffer_store_dwordx4 v[64:67], v1, s[16:19], s50 offen sc1
    s_add_u32 s50, s56, 122880
    buffer_store_dwordx4 v[68:71], v1, s[16:19], s50 offen sc1
    s_add_u32 s50, s56, 131072
    buffer_store_dwordx4 v[72:75], v1, s[16:19], s50 offen sc1
    s_add_u32 s50, s56, 139264
    buffer_store_dwordx4 v[76:79], v1, s[16:19], s50 offen sc1
    s_add_u32 s50, s56, 147456
    buffer_store_dwordx4 v[80:83], v5, s[16:19], s50 offen sc1
    s_setprio 0
    s_load_dwordx8 s[28:35], s[24:25], 0
    s_mul_i32 s48, s2, 25088
    v_add_u32 v24, s48, v1
    v_add_u32 v25, 8192, v24
    v_add_u32 v26, 16384, v24
    v_add_u32 v27, 24576, v24
    v_mov_b32 v7, s52
    v_cmp_gt_u32 vcc, 32, v0
    s_nop 1
    v_cndmask_b32 v27, v7, v27, vcc
    buffer_load_dwordx4 v[8:11], v24, s[20:23], 0 offen
    buffer_load_dwordx4 v[12:15], v25, s[20:23], 0 offen
    buffer_load_dwordx4 v[16:19], v26, s[20:23], 0 offen
    buffer_load_dwordx4 v[20:23], v27, s[20:23], 0 offen
    v_mov_b32 v5, s52
    v_mov_b32 v28, 0
    s_waitcnt lgkmcnt(0)
    s_pack_ll_b32_b16 s36, s28, s30
    s_pack_ll_b32_b16 s37, s32, s34
    s_pack_hh_b32_b16 s38, s28, s30
    s_pack_hh_b32_b16 s39, s32, s34
    s_pack_ll_b32_b16 s40, s29, s31
    s_pack_ll_b32_b16 s41, s33, s35
    s_pack_hh_b32_b16 s42, s29, s31
    s_pack_hh_b32_b16 s43, s33, s35
    s_mov_b32 s48, 81788928
    s_waitcnt vmcnt(0)
    v_dot2_f32_bf16 v32, v8, s36, 0
    v_dot2_f32_bf16 v33, v8, s38, 0
    v_dot2_f32_bf16 v34, v8, s40, 0
    v_dot2_f32_bf16 v35, v8, s42, 0
    v_dot2_f32_bf16 v32, v9, s37, v32
    v_dot2_f32_bf16 v33, v9, s39, v33
    v_dot2_f32_bf16 v34, v9, s41, v34
    v_dot2_f32_bf16 v35, v9, s43, v35
    v_dot2_f32_bf16 v36, v10, s36, 0
    v_dot2_f32_bf16 v37, v10, s38, 0
    v_dot2_f32_bf16 v38, v10, s40, 0
    v_dot2_f32_bf16 v39, v10, s42, 0
    v_dot2_f32_bf16 v36, v11, s37, v36
    v_dot2_f32_bf16 v37, v11, s39, v37
    v_dot2_f32_bf16 v38, v11, s41, v38
    v_dot2_f32_bf16 v39, v11, s43, v39
    v_dot2_f32_bf16 v40, v12, s36, 0
    v_dot2_f32_bf16 v41, v12, s38, 0
    v_dot2_f32_bf16 v42, v12, s40, 0
    v_dot2_f32_bf16 v43, v12, s42, 0
    v_dot2_f32_bf16 v40, v13, s37, v40
    v_dot2_f32_bf16 v41, v13, s39, v41
    v_dot2_f32_bf16 v42, v13, s41, v42
    v_dot2_f32_bf16 v43, v13, s43, v43
    v_dot2_f32_bf16 v44, v14, s36, 0
    v_dot2_f32_bf16 v45, v14, s38, 0
    v_dot2_f32_bf16 v46, v14, s40, 0
    v_dot2_f32_bf16 v47, v14, s42, 0
    v_dot2_f32_bf16 v44, v15, s37, v44
    v_dot2_f32_bf16 v45, v15, s39, v45
    v_dot2_f32_bf16 v46, v15, s41, v46
    v_dot2_f32_bf16 v47, v15, s43, v47
    v_dot2_f32_bf16 v48, v16, s36, 0
    v_dot2_f32_bf16 v49, v16, s38, 0
    v_dot2_f32_bf16 v50, v16, s40, 0
    v_dot2_f32_bf16 v51, v16, s42, 0
    v_dot2_f32_bf16 v48, v17, s37, v48
    v_dot2_f32_bf16 v49, v17, s39, v49
    v_dot2_f32_bf16 v50, v17, s41, v50
    v_dot2_f32_bf16 v51, v17, s43, v51
    v_dot2_f32_bf16 v52, v18, s36, 0
    v_dot2_f32_bf16 v53, v18, s38, 0
    v_dot2_f32_bf16 v54, v18, s40, 0
    v_dot2_f32_bf16 v55, v18, s42, 0
    v_dot2_f32_bf16 v52, v19, s37, v52
    v_dot2_f32_bf16 v53, v19, s39, v53
    v_dot2_f32_bf16 v54, v19, s41, v54
    v_dot2_f32_bf16 v55, v19, s43, v55
    v_dot2_f32_bf16 v56, v20, s36, 0
    v_dot2_f32_bf16 v57, v20, s38, 0
    v_dot2_f32_bf16 v58, v20, s40, 0
    v_dot2_f32_bf16 v59, v20, s42, 0
    v_dot2_f32_bf16 v56, v21, s37, v56
    v_dot2_f32_bf16 v57, v21, s39, v57
    v_dot2_f32_bf16 v58, v21, s41, v58
    v_dot2_f32_bf16 v59, v21, s43, v59
    v_dot2_f32_bf16 v60, v22, s36, 0
    v_dot2_f32_bf16 v61, v22, s38, 0
    v_dot2_f32_bf16 v62, v22, s40, 0
    v_dot2_f32_bf16 v63, v22, s42, 0
    v_dot2_f32_bf16 v60, v23, s37, v60
    v_dot2_f32_bf16 v61, v23, s39, v61
    v_dot2_f32_bf16 v62, v23, s41, v62
    v_dot2_f32_bf16 v63, v23, s43, v63
    v_max3_f32 v28, abs(v32), abs(v33), v28
    v_max3_f32 v28, abs(v34), abs(v35), v28
    v_cvt_pk_bf16_f32 v8, v32, v33
    v_cvt_pk_bf16_f32 v9, v34, v35
    v_max3_f32 v28, abs(v36), abs(v37), v28
    v_max3_f32 v28, abs(v38), abs(v39), v28
    v_cvt_pk_bf16_f32 v10, v36, v37
    v_cvt_pk_bf16_f32 v11, v38, v39
    v_max3_f32 v28, abs(v40), abs(v41), v28
    v_max3_f32 v28, abs(v42), abs(v43), v28
    v_cvt_pk_bf16_f32 v12, v40, v41
    v_cvt_pk_bf16_f32 v13, v42, v43
    v_max3_f32 v28, abs(v44), abs(v45), v28
    v_max3_f32 v28, abs(v46), abs(v47), v28
    v_cvt_pk_bf16_f32 v14, v44, v45
    v_cvt_pk_bf16_f32 v15, v46, v47
    v_max3_f32 v28, abs(v48), abs(v49), v28
    v_max3_f32 v28, abs(v50), abs(v51), v28
    v_cvt_pk_bf16_f32 v16, v48, v49
    v_cvt_pk_bf16_f32 v17, v50, v51
    v_max3_f32 v28, abs(v52), abs(v53), v28
    v_max3_f32 v28, abs(v54), abs(v55), v28
    v_cvt_pk_bf16_f32 v18, v52, v53
    v_cvt_pk_bf16_f32 v19, v54, v55
    v_max3_f32 v28, abs(v56), abs(v57), v28
    v_max3_f32 v28, abs(v58), abs(v59), v28
    v_cvt_pk_bf16_f32 v20, v56, v57
    v_cvt_pk_bf16_f32 v21, v58, v59
    v_max3_f32 v28, abs(v60), abs(v61), v28
    v_max3_f32 v28, abs(v62), abs(v63), v28
    v_cvt_pk_bf16_f32 v22, v60, v61
    v_cvt_pk_bf16_f32 v23, v62, v63
    s_mov_b32 s49, 85065728
    v_lshrrev_b32 v24, 1, v24
    v_lshrrev_b32 v25, 1, v25
    v_lshrrev_b32 v26, 1, v26
    v_lshrrev_b32 v27, 1, v27
    buffer_store_dwordx2 v[8:9], v24, s[16:19], s48 offen sc1
    buffer_store_dwordx2 v[10:11], v24, s[16:19], s49 offen sc1
    buffer_store_dwordx2 v[12:13], v25, s[16:19], s48 offen sc1
    buffer_store_dwordx2 v[14:15], v25, s[16:19], s49 offen sc1
    buffer_store_dwordx2 v[16:17], v26, s[16:19], s48 offen sc1
    buffer_store_dwordx2 v[18:19], v26, s[16:19], s49 offen sc1
    buffer_store_dwordx2 v[20:21], v27, s[16:19], s48 offen sc1
    buffer_store_dwordx2 v[22:23], v27, s[16:19], s49 offen sc1
    s_lshl_b32 s49, s2, 7
    s_add_u32 s49, s49, 89194496
    v_cmp_gt_u32 vcc, 8, v0
    s_nop 1
    v_cndmask_b32 v5, v5, v1, vcc
    buffer_store_dword v4, v5, s[16:19], s49 offen sc1
    v_add_f32 v32, abs(v32), abs(v48)
    v_add_f32 v33, abs(v33), abs(v49)
    v_add_f32 v34, abs(v34), abs(v50)
    v_add_f32 v35, abs(v35), abs(v51)
    v_add_f32 v36, abs(v36), abs(v52)
    v_add_f32 v37, abs(v37), abs(v53)
    v_add_f32 v38, abs(v38), abs(v54)
    v_add_f32 v39, abs(v39), abs(v55)
    v_add_f32 v40, abs(v40), abs(v56)
    v_add_f32 v41, abs(v41), abs(v57)
    v_add_f32 v42, abs(v42), abs(v58)
    v_add_f32 v43, abs(v43), abs(v59)
    v_add_f32 v44, abs(v44), abs(v60)
    v_add_f32 v45, abs(v45), abs(v61)
    v_add_f32 v46, abs(v46), abs(v62)
    v_add_f32 v47, abs(v47), abs(v63)
    v_add_f32 v32, abs(v32), abs(v40)
    v_add_f32 v33, abs(v33), abs(v41)
    v_add_f32 v34, abs(v34), abs(v42)
    v_add_f32 v35, abs(v35), abs(v43)
    v_add_f32 v36, abs(v36), abs(v44)
    v_add_f32 v37, abs(v37), abs(v45)
    v_add_f32 v38, abs(v38), abs(v46)
    v_add_f32 v39, abs(v39), abs(v47)
    v_add_f32 v32, abs(v32), abs(v36)
    v_add_f32 v33, abs(v33), abs(v37)
    v_add_f32 v34, abs(v34), abs(v38)
    v_add_f32 v35, abs(v35), abs(v39)
    v_add_f32 v32, abs(v32), abs(v34)
    v_add_f32 v33, abs(v33), abs(v35)
    v_add_f32 v32, abs(v32), abs(v33)
    s_nop 1
    v_add_f32_dpp v32, v32, v32 row_shr:1 row_mask:0xf bank_mask:0xf bound_ctrl:0
    s_nop 1
    v_add_f32_dpp v32, v32, v32 row_shr:2 row_mask:0xf bank_mask:0xf bound_ctrl:0
    s_nop 1
    v_add_f32_dpp v32, v32, v32 row_shr:4 row_mask:0xf bank_mask:0xf bound_ctrl:0
    s_nop 1
    v_add_f32_dpp v32, v32, v32 row_shr:8 row_mask:0xf bank_mask:0xf bound_ctrl:0
    s_nop 1
    v_add_f32_dpp v32, v32, v32 row_bcast:15 row_mask:0xa bank_mask:0xf
    s_nop 1
    v_add_f32_dpp v32, v32, v32 row_bcast:31 row_mask:0xc bank_mask:0xf
    v_max_u32_dpp v28, v28, v28 row_shr:1 row_mask:0xf bank_mask:0xf bound_ctrl:0
    s_nop 1
    v_max_u32_dpp v28, v28, v28 row_shr:2 row_mask:0xf bank_mask:0xf bound_ctrl:0
    s_nop 1
    v_max_u32_dpp v28, v28, v28 row_shr:4 row_mask:0xf bank_mask:0xf bound_ctrl:0
    s_nop 1
    v_max_u32_dpp v28, v28, v28 row_shr:8 row_mask:0xf bank_mask:0xf bound_ctrl:0
    s_nop 1
    v_max_u32_dpp v28, v28, v28 row_bcast:15 row_mask:0xa bank_mask:0xf
    s_nop 1
    v_max_u32_dpp v28, v28, v28 row_bcast:31 row_mask:0xc bank_mask:0xf
    s_lshl_b64 exec, 1, 63
    ds_add_f32 v4, v32 offset:8260
    ds_max_u32 v4, v28 offset:8256
    s_mov_b64 exec, -1
    s_mov_b64 exec, 1
    ds_add_rtn_u32 v7, v4, v3 offset:8240
    ds_read_b64 v[30:31], v4 offset:8256
    s_lshl_b32 s48, s2, 3
    s_add_u32 s48, s48, 89128960
    v_mov_b32 v5, s52
    s_waitcnt lgkmcnt(0)
    v_cmp_eq_u32 vcc, 7, v7
    s_nop 1
    v_cndmask_b32 v5, v5, v4, vcc
    buffer_store_dwordx2 v[30:31], v5, s[16:19], s48 offen sc1
    s_mov_b64 exec, -1
    s_endpgm
K1_Q:
    s_setprio 0
    v_mov_b32 v3, 65536
    s_add_u32 s48, s54, 0
    s_add_u32 s49, s55, 0
    buffer_load_dwordx4 v[8:11], v1, s[4:7], s48 offen nt
    buffer_load_dwordx4 v[12:15], v1, s[8:11], s48 offen nt
    buffer_load_dwordx2 v[106:107], v2, s[12:15], s49 offen nt
    s_add_u32 s48, s54, 8192
    s_add_u32 s49, s55, 4096
    buffer_load_dwordx4 v[16:19], v1, s[4:7], s48 offen nt
    buffer_load_dwordx4 v[20:23], v1, s[8:11], s48 offen nt
    buffer_load_dwordx2 v[108:109], v2, s[12:15], s49 offen nt
    s_add_u32 s48, s54, 16384
    s_add_u32 s49, s55, 8192
    buffer_load_dwordx4 v[24:27], v1, s[4:7], s48 offen nt
    buffer_load_dwordx4 v[28:31], v1, s[8:11], s48 offen nt
    buffer_load_dwordx2 v[110:111], v2, s[12:15], s49 offen nt
    s_add_u32 s48, s54, 24576
    s_add_u32 s49, s55, 12288
    buffer_load_dwordx4 v[32:35], v1, s[4:7], s48 offen nt
    buffer_load_dwordx4 v[36:39], v1, s[8:11], s48 offen nt
    buffer_load_dwordx2 v[112:113], v2, s[12:15], s49 offen nt
    s_add_u32 s48, s54, 32768
    s_add_u32 s49, s55, 16384
    buffer_load_dwordx4 v[40:43], v1, s[4:7], s48 offen nt
    buffer_load_dwordx4 v[44:47], v1, s[8:11], s48 offen nt
    buffer_load_dwordx2 v[114:115], v2, s[12:15], s49 offen nt
    s_waitcnt vmcnt(13)
    v_mul_hi_u32_u24 v116, s45, v12
    v_mul_hi_u32_u24 v120, s46, v8
    v_lshlrev_b32 v12, 1, v12
    v_and_b32 v116, 0x1fc, v116
    v_bfi_b32 v120, 1, v8, v120
    v_mad_i32_i24 v12, v116, s47, v12
    v_lshrrev_b32 v8, 1, v8
    v_lshl_or_b32 v116, v120, 9, v116
    v_lshl_or_b32 v8, v12, 18, v8
    ds_add_u32 v116, v3
    v_mul_hi_u32_u24 v117, s45, v13
    v_mul_hi_u32_u24 v121, s46, v9
    v_lshlrev_b32 v13, 1, v13
    v_and_b32 v117, 0x1fc, v117
    v_bfi_b32 v121, 1, v9, v121
    v_mad_i32_i24 v13, v117, s47, v13
    v_lshrrev_b32 v9, 1, v9
    v_lshl_or_b32 v117, v121, 9, v117
    v_lshl_or_b32 v9, v13, 18, v9
    ds_add_u32 v117, v3
    v_mul_hi_u32_u24 v118, s45, v14
    v_mul_hi_u32_u24 v122, s46, v10
    v_lshlrev_b32 v14, 1, v14
    v_and_b32 v118, 0x1fc, v118
    v_bfi_b32 v122, 1, v10, v122
    v_mad_i32_i24 v14, v118, s47, v14
    v_lshrrev_b32 v10, 1, v10
    v_lshl_or_b32 v118, v122, 9, v118
    v_lshl_or_b32 v10, v14, 18, v10
    ds_add_u32 v118, v3
    v_mul_hi_u32_u24 v119, s45, v15
    v_mul_hi_u32_u24 v123, s46, v11
    v_lshlrev_b32 v15, 1, v15
    v_and_b32 v119, 0x1fc, v119
    v_bfi_b32 v123, 1, v11, v123
    v_mad_i32_i24 v15, v119, s47, v15
    v_lshrrev_b32 v11, 1, v11
    v_lshl_or_b32 v119, v123, 9, v119
    v_lshl_or_b32 v11, v15, 18, v11
    ds_add_u32 v119, v3
    s_waitcnt vmcnt(12)
    v_lshl_or_b32 v12, v106, 16, v116
    v_and_or_b32 v13, v106, s59, v117
    v_lshl_or_b32 v14, v107, 16, v118
    v_and_or_b32 v15, v107, s59, v119
    s_add_u32 s48, s54, 40960
    s_add_u32 s49, s55, 20480
    buffer_load_dwordx4 v[48:51], v1, s[4:7], s48 offen nt
    buffer_load_dwordx4 v[52:55], v1, s[8:11], s48 offen nt
    buffer_load_dwordx2 v[106:107], v2, s[12:15], s49 offen nt
    s_waitcnt vmcnt(13)
    v_mul_hi_u32_u24 v116, s45, v20
    v_mul_hi_u32_u24 v120, s46, v16
    v_lshlrev_b32 v20, 1, v20
    v_and_b32 v116, 0x1fc, v116
    v_bfi_b32 v120, 1, v16, v120
    v_mad_i32_i24 v20, v116, s47, v20
    v_lshrrev_b32 v16, 1, v16
    v_lshl_or_b32 v116, v120, 9, v116
    v_lshl_or_b32 v16, v20, 18, v16
    ds_add_u32 v116, v3
    v_mul_hi_u32_u24 v117, s45, v21
    v_mul_hi_u32_u24 v121, s46, v17
    v_lshlrev_b32 v21, 1, v21
    v_and_b32 v117, 0x1fc, v117
    v_bfi_b32 v121, 1, v17, v121
    v_mad_i32_i24 v21, v117, s47, v21
    v_lshrrev_b32 v17, 1, v17
    v_lshl_or_b32 v117, v121, 9, v117
    v_lshl_or_b32 v17, v21, 18, v17
    ds_add_u32 v117, v3
    v_mul_hi_u32_u24 v118, s45, v22
    v_mul_hi_u32_u24 v122, s46, v18
    v_lshlrev_b32 v22, 1, v22
    v_and_b32 v118, 0x1fc, v118
    v_bfi_b32 v122, 1, v18, v122
    v_mad_i32_i24 v22, v118, s47, v22
    v_lshrrev_b32 v18, 1, v18
    v_lshl_or_b32 v118, v122, 9, v118
    v_lshl_or_b32 v18, v22, 18, v18
    ds_add_u32 v118, v3
    v_mul_hi_u32_u24 v119, s45, v23
    v_mul_hi_u32_u24 v123, s46, v19
    v_lshlrev_b32 v23, 1, v23
    v_and_b32 v119, 0x1fc, v119
    v_bfi_b32 v123, 1, v19, v123
    v_mad_i32_i24 v23, v119, s47, v23
    v_lshrrev_b32 v19, 1, v19
    v_lshl_or_b32 v119, v123, 9, v119
    v_lshl_or_b32 v19, v23, 18, v19
    ds_add_u32 v119, v3
    s_waitcnt vmcnt(12)
    v_lshl_or_b32 v20, v108, 16, v116
    v_and_or_b32 v21, v108, s59, v117
    v_lshl_or_b32 v22, v109, 16, v118
    v_and_or_b32 v23, v109, s59, v119
    s_add_u32 s48, s54, 49152
    s_add_u32 s49, s55, 24576
    buffer_load_dwordx4 v[56:59], v1, s[4:7], s48 offen nt
    buffer_load_dwordx4 v[60:63], v1, s[8:11], s48 offen nt
    buffer_load_dwordx2 v[108:109], v2, s[12:15], s49 offen nt
    s_waitcnt vmcnt(13)
    v_mul_hi_u32_u24 v116, s45, v28
    v_mul_hi_u32_u24 v120, s46, v24
    v_lshlrev_b32 v28, 1, v28
    v_and_b32 v116, 0x1fc, v116
    v_bfi_b32 v120, 1, v24, v120
    v_mad_i32_i24 v28, v116, s47, v28
    v_lshrrev_b32 v24, 1, v24
    v_lshl_or_b32 v116, v120, 9, v116
    v_lshl_or_b32 v24, v28, 18, v24
    ds_add_u32 v116, v3
    v_mul_hi_u32_u24 v117, s45, v29
    v_mul_hi_u32_u24 v121, s46, v25
    v_lshlrev_b32 v29, 1, v29
    v_and_b32 v117, 0x1fc, v117
    v_bfi_b32 v121, 1, v25, v121
    v_mad_i32_i24 v29, v117, s47, v29
    v_lshrrev_b32 v25, 1, v25
    v_lshl_or_b32 v117, v121, 9, v117
    v_lshl_or_b32 v25, v29, 18, v25
    ds_add_u32 v117, v3
    v_mul_hi_u32_u24 v118, s45, v30
    v_mul_hi_u32_u24 v122, s46, v26
    v_lshlrev_b32 v30, 1, v30
    v_and_b32 v118, 0x1fc, v118
    v_bfi_b32 v122, 1, v26, v122
    v_mad_i32_i24 v30, v118, s47, v30
    v_lshrrev_b32 v26, 1, v26
    v_lshl_or_b32 v118, v122, 9, v118
    v_lshl_or_b32 v26, v30, 18, v26
    ds_add_u32 v118, v3
    v_mul_hi_u32_u24 v119, s45, v31
    v_mul_hi_u32_u24 v123, s46, v27
    v_lshlrev_b32 v31, 1, v31
    v_and_b32 v119, 0x1fc, v119
    v_bfi_b32 v123, 1, v27, v123
    v_mad_i32_i24 v31, v119, s47, v31
    v_lshrrev_b32 v27, 1, v27
    v_lshl_or_b32 v119, v123, 9, v119
    v_lshl_or_b32 v27, v31, 18, v27
    ds_add_u32 v119, v3
    s_waitcnt vmcnt(12)
    v_lshl_or_b32 v28, v110, 16, v116
    v_and_or_b32 v29, v110, s59, v117
    v_lshl_or_b32 v30, v111, 16, v118
    v_and_or_b32 v31, v111, s59, v119
    s_add_u32 s48, s54, 57344
    s_add_u32 s49, s55, 28672
    buffer_load_dwordx4 v[64:67], v1, s[4:7], s48 offen nt
    buffer_load_dwordx4 v[68:71], v1, s[8:11], s48 offen nt
    buffer_load_dwordx2 v[110:111], v2, s[12:15], s49 offen nt
    s_waitcnt vmcnt(13)
    v_mul_hi_u32_u24 v116, s45, v36
    v_mul_hi_u32_u24 v120, s46, v32
    v_lshlrev_b32 v36, 1, v36
    v_and_b32 v116, 0x1fc, v116
    v_bfi_b32 v120, 1, v32, v120
    v_mad_i32_i24 v36, v116, s47, v36
    v_lshrrev_b32 v32, 1, v32
    v_lshl_or_b32 v116, v120, 9, v116
    v_lshl_or_b32 v32, v36, 18, v32
    ds_add_u32 v116, v3
    v_mul_hi_u32_u24 v117, s45, v37
    v_mul_hi_u32_u24 v121, s46, v33
    v_lshlrev_b32 v37, 1, v37
    v_and_b32 v117, 0x1fc, v117
    v_bfi_b32 v121, 1, v33, v121
    v_mad_i32_i24 v37, v117, s47, v37
    v_lshrrev_b32 v33, 1, v33
    v_lshl_or_b32 v117, v121, 9, v117
    v_lshl_or_b32 v33, v37, 18, v33
    ds_add_u32 v117, v3
    v_mul_hi_u32_u24 v118, s45, v38
    v_mul_hi_u32_u24 v122, s46, v34
    v_lshlrev_b32 v38, 1, v38
    v_and_b32 v118, 0x1fc, v118
    v_bfi_b32 v122, 1, v34, v122
    v_mad_i32_i24 v38, v118, s47, v38
    v_lshrrev_b32 v34, 1, v34
    v_lshl_or_b32 v118, v122, 9, v118
    v_lshl_or_b32 v34, v38, 18, v34
    ds_add_u32 v118, v3
    v_mul_hi_u32_u24 v119, s45, v39
    v_mul_hi_u32_u24 v123, s46, v35
    v_lshlrev_b32 v39, 1, v39
    v_and_b32 v119, 0x1fc, v119
    v_bfi_b32 v123, 1, v35, v123
    v_mad_i32_i24 v39, v119, s47, v39
    v_lshrrev_b32 v35, 1, v35
    v_lshl_or_b32 v119, v123, 9, v119
    v_lshl_or_b32 v35, v39, 18, v35
    ds_add_u32 v119, v3
    s_waitcnt vmcnt(12)
    v_lshl_or_b32 v36, v112, 16, v116
    v_and_or_b32 v37, v112, s59, v117
    v_lshl_or_b32 v38, v113, 16, v118
    v_and_or_b32 v39, v113, s59, v119
    s_add_u32 s48, s54, 65536
    s_add_u32 s49, s55, 32768
    buffer_load_dwordx4 v[72:75], v1, s[4:7], s48 offen nt
    buffer_load_dwordx4 v[76:79], v1, s[8:11], s48 offen nt
    buffer_load_dwordx2 v[112:113], v2, s[12:15], s49 offen nt
    s_waitcnt vmcnt(13)
    v_mul_hi_u32_u24 v116, s45, v44
    v_mul_hi_u32_u24 v120, s46, v40
    v_lshlrev_b32 v44, 1, v44
    v_and_b32 v116, 0x1fc, v116
    v_bfi_b32 v120, 1, v40, v120
    v_mad_i32_i24 v44, v116, s47, v44
    v_lshrrev_b32 v40, 1, v40
    v_lshl_or_b32 v116, v120, 9, v116
    v_lshl_or_b32 v40, v44, 18, v40
    ds_add_u32 v116, v3
    v_mul_hi_u32_u24 v117, s45, v45
    v_mul_hi_u32_u24 v121, s46, v41
    v_lshlrev_b32 v45, 1, v45
    v_and_b32 v117, 0x1fc, v117
    v_bfi_b32 v121, 1, v41, v121
    v_mad_i32_i24 v45, v117, s47, v45
    v_lshrrev_b32 v41, 1, v41
    v_lshl_or_b32 v117, v121, 9, v117
    v_lshl_or_b32 v41, v45, 18, v41
    ds_add_u32 v117, v3
    v_mul_hi_u32_u24 v118, s45, v46
    v_mul_hi_u32_u24 v122, s46, v42
    v_lshlrev_b32 v46, 1, v46
    v_and_b32 v118, 0x1fc, v118
    v_bfi_b32 v122, 1, v42, v122
    v_mad_i32_i24 v46, v118, s47, v46
    v_lshrrev_b32 v42, 1, v42
    v_lshl_or_b32 v118, v122, 9, v118
    v_lshl_or_b32 v42, v46, 18, v42
    ds_add_u32 v118, v3
    v_mul_hi_u32_u24 v119, s45, v47
    v_mul_hi_u32_u24 v123, s46, v43
    v_lshlrev_b32 v47, 1, v47
    v_and_b32 v119, 0x1fc, v119
    v_bfi_b32 v123, 1, v43, v123
    v_mad_i32_i24 v47, v119, s47, v47
    v_lshrrev_b32 v43, 1, v43
    v_lshl_or_b32 v119, v123, 9, v119
    v_lshl_or_b32 v43, v47, 18, v43
    ds_add_u32 v119, v3
    s_waitcnt vmcnt(12)
    v_lshl_or_b32 v44, v114, 16, v116
    v_and_or_b32 v45, v114, s59, v117
    v_lshl_or_b32 v46, v115, 16, v118
    v_and_or_b32 v47, v115, s59, v119
    s_add_u32 s48, s54, 73728
    s_add_u32 s49, s55, 36864
    buffer_load_dwordx4 v[80:83], v1, s[4:7], s48 offen nt
    buffer_load_dwordx4 v[84:87], v1, s[8:11], s48 offen nt
    buffer_load_dwordx2 v[114:115], v2, s[12:15], s49 offen nt
    s_waitcnt vmcnt(13)
    v_mul_hi_u32_u24 v116, s45, v52
    v_mul_hi_u32_u24 v120, s46, v48
    v_lshlrev_b32 v52, 1, v52
    v_and_b32 v116, 0x1fc, v116
    v_bfi_b32 v120, 1, v48, v120
    v_mad_i32_i24 v52, v116, s47, v52
    v_lshrrev_b32 v48, 1, v48
    v_lshl_or_b32 v116, v120, 9, v116
    v_lshl_or_b32 v48, v52, 18, v48
    ds_add_u32 v116, v3
    v_mul_hi_u32_u24 v117, s45, v53
    v_mul_hi_u32_u24 v121, s46, v49
    v_lshlrev_b32 v53, 1, v53
    v_and_b32 v117, 0x1fc, v117
    v_bfi_b32 v121, 1, v49, v121
    v_mad_i32_i24 v53, v117, s47, v53
    v_lshrrev_b32 v49, 1, v49
    v_lshl_or_b32 v117, v121, 9, v117
    v_lshl_or_b32 v49, v53, 18, v49
    ds_add_u32 v117, v3
    v_mul_hi_u32_u24 v118, s45, v54
    v_mul_hi_u32_u24 v122, s46, v50
    v_lshlrev_b32 v54, 1, v54
    v_and_b32 v118, 0x1fc, v118
    v_bfi_b32 v122, 1, v50, v122
    v_mad_i32_i24 v54, v118, s47, v54
    v_lshrrev_b32 v50, 1, v50
    v_lshl_or_b32 v118, v122, 9, v118
    v_lshl_or_b32 v50, v54, 18, v50
    ds_add_u32 v118, v3
    v_mul_hi_u32_u24 v119, s45, v55
    v_mul_hi_u32_u24 v123, s46, v51
    v_lshlrev_b32 v55, 1, v55
    v_and_b32 v119, 0x1fc, v119
    v_bfi_b32 v123, 1, v51, v123
    v_mad_i32_i24 v55, v119, s47, v55
    v_lshrrev_b32 v51, 1, v51
    v_lshl_or_b32 v119, v123, 9, v119
    v_lshl_or_b32 v51, v55, 18, v51
    ds_add_u32 v119, v3
    s_waitcnt vmcnt(12)
    v_lshl_or_b32 v52, v106, 16, v116
    v_and_or_b32 v53, v106, s59, v117
    v_lshl_or_b32 v54, v107, 16, v118
    v_and_or_b32 v55, v107, s59, v119
    s_add_u32 s48, s54, 81920
    s_add_u32 s49, s55, 40960
    buffer_load_dwordx4 v[88:91], v1, s[4:7], s48 offen nt
    buffer_load_dwordx4 v[92:95], v1, s[8:11], s48 offen nt
    buffer_load_dwordx2 v[106:107], v2, s[12:15], s49 offen nt
    s_waitcnt vmcnt(13)
    v_mul_hi_u32_u24 v116, s45, v60
    v_mul_hi_u32_u24 v120, s46, v56
    v_lshlrev_b32 v60, 1, v60
    v_and_b32 v116, 0x1fc, v116
    v_bfi_b32 v120, 1, v56, v120
    v_mad_i32_i24 v60, v116, s47, v60
    v_lshrrev_b32 v56, 1, v56
    v_lshl_or_b32 v116, v120, 9, v116
    v_lshl_or_b32 v56, v60, 18, v56
    ds_add_u32 v116, v3
    v_mul_hi_u32_u24 v117, s45, v61
    v_mul_hi_u32_u24 v121, s46, v57
    v_lshlrev_b32 v61, 1, v61
    v_and_b32 v117, 0x1fc, v117
    v_bfi_b32 v121, 1, v57, v121
    v_mad_i32_i24 v61, v117, s47, v61
    v_lshrrev_b32 v57, 1, v57
    v_lshl_or_b32 v117, v121, 9, v117
    v_lshl_or_b32 v57, v61, 18, v57
    ds_add_u32 v117, v3
    v_mul_hi_u32_u24 v118, s45, v62
    v_mul_hi_u32_u24 v122, s46, v58
    v_lshlrev_b32 v62, 1, v62
    v_and_b32 v118, 0x1fc, v118
    v_bfi_b32 v122, 1, v58, v122
    v_mad_i32_i24 v62, v118, s47, v62
    v_lshrrev_b32 v58, 1, v58
    v_lshl_or_b32 v118, v122, 9, v118
    v_lshl_or_b32 v58, v62, 18, v58
    ds_add_u32 v118, v3
    v_mul_hi_u32_u24 v119, s45, v63
    v_mul_hi_u32_u24 v123, s46, v59
    v_lshlrev_b32 v63, 1, v63
    v_and_b32 v119, 0x1fc, v119
    v_bfi_b32 v123, 1, v59, v123
    v_mad_i32_i24 v63, v119, s47, v63
    v_lshrrev_b32 v59, 1, v59
    v_lshl_or_b32 v119, v123, 9, v119
    v_lshl_or_b32 v59, v63, 18, v59
    ds_add_u32 v119, v3
    s_waitcnt vmcnt(12)
    v_lshl_or_b32 v60, v108, 16, v116
    v_and_or_b32 v61, v108, s59, v117
    v_lshl_or_b32 v62, v109, 16, v118
    v_and_or_b32 v63, v109, s59, v119
    s_add_u32 s48, s54, 90112
    s_add_u32 s49, s55, 45056
    buffer_load_dwordx4 v[96:99], v1, s[4:7], s48 offen nt
    buffer_load_dwordx4 v[100:103], v1, s[8:11], s48 offen nt
    buffer_load_dwordx2 v[108:109], v2, s[12:15], s49 offen nt
    s_waitcnt vmcnt(13)
    v_mul_hi_u32_u24 v116, s45, v68
    v_mul_hi_u32_u24 v120, s46, v64
    v_lshlrev_b32 v68, 1, v68
    v_and_b32 v116, 0x1fc, v116
    v_bfi_b32 v120, 1, v64, v120
    v_mad_i32_i24 v68, v116, s47, v68
    v_lshrrev_b32 v64, 1, v64
    v_lshl_or_b32 v116, v120, 9, v116
    v_lshl_or_b32 v64, v68, 18, v64
    ds_add_u32 v116, v3
    v_mul_hi_u32_u24 v117, s45, v69
    v_mul_hi_u32_u24 v121, s46, v65
    v_lshlrev_b32 v69, 1, v69
    v_and_b32 v117, 0x1fc, v117
    v_bfi_b32 v121, 1, v65, v121
    v_mad_i32_i24 v69, v117, s47, v69
    v_lshrrev_b32 v65, 1, v65
    v_lshl_or_b32 v117, v121, 9, v117
    v_lshl_or_b32 v65, v69, 18, v65
    ds_add_u32 v117, v3
    v_mul_hi_u32_u24 v118, s45, v70
    v_mul_hi_u32_u24 v122, s46, v66
    v_lshlrev_b32 v70, 1, v70
    v_and_b32 v118, 0x1fc, v118
    v_bfi_b32 v122, 1, v66, v122
    v_mad_i32_i24 v70, v118, s47, v70
    v_lshrrev_b32 v66, 1, v66
    v_lshl_or_b32 v118, v122, 9, v118
    v_lshl_or_b32 v66, v70, 18, v66
    ds_add_u32 v118, v3
    v_mul_hi_u32_u24 v119, s45, v71
    v_mul_hi_u32_u24 v123, s46, v67
    v_lshlrev_b32 v71, 1, v71
    v_and_b32 v119, 0x1fc, v119
    v_bfi_b32 v123, 1, v67, v123
    v_mad_i32_i24 v71, v119, s47, v71
    v_lshrrev_b32 v67, 1, v67
    v_lshl_or_b32 v119, v123, 9, v119
    v_lshl_or_b32 v67, v71, 18, v67
    ds_add_u32 v119, v3
    s_waitcnt vmcnt(12)
    v_lshl_or_b32 v68, v110, 16, v116
    v_and_or_b32 v69, v110, s59, v117
    v_lshl_or_b32 v70, v111, 16, v118
    v_and_or_b32 v71, v111, s59, v119
    s_add_u32 s48, s54, 98304
    s_add_u32 s49, s55, 49152
    v_lshl_or_b32 v124, v0, 2, s58
    v_lshl_or_b32 v125, v0, 1, s58
    buffer_load_dword v104, v124, s[4:7], s48 offen nt
    buffer_load_dword v105, v124, s[8:11], s48 offen nt
    buffer_load_ushort v110, v125, s[12:15], s49 offen nt
    s_waitcnt vmcnt(13)
    v_mul_hi_u32_u24 v116, s45, v76
    v_mul_hi_u32_u24 v120, s46, v72
    v_lshlrev_b32 v76, 1, v76
    v_and_b32 v116, 0x1fc, v116
    v_bfi_b32 v120, 1, v72, v120
    v_mad_i32_i24 v76, v116, s47, v76
    v_lshrrev_b32 v72, 1, v72
    v_lshl_or_b32 v116, v120, 9, v116
    v_lshl_or_b32 v72, v76, 18, v72
    ds_add_u32 v116, v3
    v_mul_hi_u32_u24 v117, s45, v77
    v_mul_hi_u32_u24 v121, s46, v73
    v_lshlrev_b32 v77, 1, v77
    v_and_b32 v117, 0x1fc, v117
    v_bfi_b32 v121, 1, v73, v121
    v_mad_i32_i24 v77, v117, s47, v77
    v_lshrrev_b32 v73, 1, v73
    v_lshl_or_b32 v117, v121, 9, v117
    v_lshl_or_b32 v73, v77, 18, v73
    ds_add_u32 v117, v3
    v_mul_hi_u32_u24 v118, s45, v78
    v_mul_hi_u32_u24 v122, s46, v74
    v_lshlrev_b32 v78, 1, v78
    v_and_b32 v118, 0x1fc, v118
    v_bfi_b32 v122, 1, v74, v122
    v_mad_i32_i24 v78, v118, s47, v78
    v_lshrrev_b32 v74, 1, v74
    v_lshl_or_b32 v118, v122, 9, v118
    v_lshl_or_b32 v74, v78, 18, v74
    ds_add_u32 v118, v3
    v_mul_hi_u32_u24 v119, s45, v79
    v_mul_hi_u32_u24 v123, s46, v75
    v_lshlrev_b32 v79, 1, v79
    v_and_b32 v119, 0x1fc, v119
    v_bfi_b32 v123, 1, v75, v123
    v_mad_i32_i24 v79, v119, s47, v79
    v_lshrrev_b32 v75, 1, v75
    v_lshl_or_b32 v119, v123, 9, v119
    v_lshl_or_b32 v75, v79, 18, v75
    ds_add_u32 v119, v3
    s_waitcnt vmcnt(12)
    v_lshl_or_b32 v76, v112, 16, v116
    v_and_or_b32 v77, v112, s59, v117
    v_lshl_or_b32 v78, v113, 16, v118
    v_and_or_b32 v79, v113, s59, v119
    s_waitcnt vmcnt(10)
    v_mul_hi_u32_u24 v116, s45, v84
    v_mul_hi_u32_u24 v120, s46, v80
    v_lshlrev_b32 v84, 1, v84
    v_and_b32 v116, 0x1fc, v116
    v_bfi_b32 v120, 1, v80, v120
    v_mad_i32_i24 v84, v116, s47, v84
    v_lshrrev_b32 v80, 1, v80
    v_lshl_or_b32 v116, v120, 9, v116
    v_lshl_or_b32 v80, v84, 18, v80
    ds_add_u32 v116, v3
    v_mul_hi_u32_u24 v117, s45, v85
    v_mul_hi_u32_u24 v121, s46, v81
    v_lshlrev_b32 v85, 1, v85
    v_and_b32 v117, 0x1fc, v117
    v_bfi_b32 v121, 1, v81, v121
    v_mad_i32_i24 v85, v117, s47, v85
    v_lshrrev_b32 v81, 1, v81
    v_lshl_or_b32 v117, v121, 9, v117
    v_lshl_or_b32 v81, v85, 18, v81
    ds_add_u32 v117, v3
    v_mul_hi_u32_u24 v118, s45, v86
    v_mul_hi_u32_u24 v122, s46, v82
    v_lshlrev_b32 v86, 1, v86
    v_and_b32 v118, 0x1fc, v118
    v_bfi_b32 v122, 1, v82, v122
    v_mad_i32_i24 v86, v118, s47, v86
    v_lshrrev_b32 v82, 1, v82
    v_lshl_or_b32 v118, v122, 9, v118
    v_lshl_or_b32 v82, v86, 18, v82
    ds_add_u32 v118, v3
    v_mul_hi_u32_u24 v119, s45, v87
    v_mul_hi_u32_u24 v123, s46, v83
    v_lshlrev_b32 v87, 1, v87
    v_and_b32 v119, 0x1fc, v119
    v_bfi_b32 v123, 1, v83, v123
    v_mad_i32_i24 v87, v119, s47, v87
    v_lshrrev_b32 v83, 1, v83
    v_lshl_or_b32 v119, v123, 9, v119
    v_lshl_or_b32 v83, v87, 18, v83
    ds_add_u32 v119, v3
    s_waitcnt vmcnt(9)
    v_lshl_or_b32 v84, v114, 16, v116
    v_and_or_b32 v85, v114, s59, v117
    v_lshl_or_b32 v86, v115, 16, v118
    v_and_or_b32 v87, v115, s59, v119
    s_waitcnt vmcnt(7)
    v_mul_hi_u32_u24 v116, s45, v92
    v_mul_hi_u32_u24 v120, s46, v88
    v_lshlrev_b32 v92, 1, v92
    v_and_b32 v116, 0x1fc, v116
    v_bfi_b32 v120, 1, v88, v120
    v_mad_i32_i24 v92, v116, s47, v92
    v_lshrrev_b32 v88, 1, v88
    v_lshl_or_b32 v116, v120, 9, v116
    v_lshl_or_b32 v88, v92, 18, v88
    ds_add_u32 v116, v3
    v_mul_hi_u32_u24 v117, s45, v93
    v_mul_hi_u32_u24 v121, s46, v89
    v_lshlrev_b32 v93, 1, v93
    v_and_b32 v117, 0x1fc, v117
    v_bfi_b32 v121, 1, v89, v121
    v_mad_i32_i24 v93, v117, s47, v93
    v_lshrrev_b32 v89, 1, v89
    v_lshl_or_b32 v117, v121, 9, v117
    v_lshl_or_b32 v89, v93, 18, v89
    ds_add_u32 v117, v3
    v_mul_hi_u32_u24 v118, s45, v94
    v_mul_hi_u32_u24 v122, s46, v90
    v_lshlrev_b32 v94, 1, v94
    v_and_b32 v118, 0x1fc, v118
    v_bfi_b32 v122, 1, v90, v122
    v_mad_i32_i24 v94, v118, s47, v94
    v_lshrrev_b32 v90, 1, v90
    v_lshl_or_b32 v118, v122, 9, v118
    v_lshl_or_b32 v90, v94, 18, v90
    ds_add_u32 v118, v3
    v_mul_hi_u32_u24 v119, s45, v95
    v_mul_hi_u32_u24 v123, s46, v91
    v_lshlrev_b32 v95, 1, v95
    v_and_b32 v119, 0x1fc, v119
    v_bfi_b32 v123, 1, v91, v123
    v_mad_i32_i24 v95, v119, s47, v95
    v_lshrrev_b32 v91, 1, v91
    v_lshl_or_b32 v119, v123, 9, v119
    v_lshl_or_b32 v91, v95, 18, v91
    ds_add_u32 v119, v3
    s_waitcnt vmcnt(6)
    v_lshl_or_b32 v92, v106, 16, v116
    v_and_or_b32 v93, v106, s59, v117
    v_lshl_or_b32 v94, v107, 16, v118
    v_and_or_b32 v95, v107, s59, v119
    s_waitcnt vmcnt(4)
    v_mul_hi_u32_u24 v116, s45, v100
    v_mul_hi_u32_u24 v120, s46, v96
    v_lshlrev_b32 v100, 1, v100
    v_and_b32 v116, 0x1fc, v116
    v_bfi_b32 v120, 1, v96, v120
    v_mad_i32_i24 v100, v116, s47, v100
    v_lshrrev_b32 v96, 1, v96
    v_lshl_or_b32 v116, v120, 9, v116
    v_lshl_or_b32 v96, v100, 18, v96
    ds_add_u32 v116, v3
    v_mul_hi_u32_u24 v117, s45, v101
    v_mul_hi_u32_u24 v121, s46, v97
    v_lshlrev_b32 v101, 1, v101
    v_and_b32 v117, 0x1fc, v117
    v_bfi_b32 v121, 1, v97, v121
    v_mad_i32_i24 v101, v117, s47, v101
    v_lshrrev_b32 v97, 1, v97
    v_lshl_or_b32 v117, v121, 9, v117
    v_lshl_or_b32 v97, v101, 18, v97
    ds_add_u32 v117, v3
    v_mul_hi_u32_u24 v118, s45, v102
    v_mul_hi_u32_u24 v122, s46, v98
    v_lshlrev_b32 v102, 1, v102
    v_and_b32 v118, 0x1fc, v118
    v_bfi_b32 v122, 1, v98, v122
    v_mad_i32_i24 v102, v118, s47, v102
    v_lshrrev_b32 v98, 1, v98
    v_lshl_or_b32 v118, v122, 9, v118
    v_lshl_or_b32 v98, v102, 18, v98
    ds_add_u32 v118, v3
    v_mul_hi_u32_u24 v119, s45, v103
    v_mul_hi_u32_u24 v123, s46, v99
    v_lshlrev_b32 v103, 1, v103
    v_and_b32 v119, 0x1fc, v119
    v_bfi_b32 v123, 1, v99, v123
    v_mad_i32_i24 v103, v119, s47, v103
    v_lshrrev_b32 v99, 1, v99
    v_lshl_or_b32 v119, v123, 9, v119
    v_lshl_or_b32 v99, v103, 18, v99
    ds_add_u32 v119, v3
    s_waitcnt vmcnt(3)
    v_lshl_or_b32 v100, v108, 16, v116
    v_and_or_b32 v101, v108, s59, v117
    v_lshl_or_b32 v102, v109, 16, v118
    v_and_or_b32 v103, v109, s59, v119
    s_waitcnt vmcnt(1)
    s_cmp_eq_u32 s58, 0
    s_cselect_b64 exec, -1, 0
    v_mul_hi_u32_u24 v116, s45, v105
    v_mul_hi_u32_u24 v120, s46, v104
    v_lshlrev_b32 v105, 1, v105
    v_and_b32 v116, 0x1fc, v116
    v_bfi_b32 v120, 1, v104, v120
    v_mad_i32_i24 v105, v116, s47, v105
    v_lshrrev_b32 v104, 1, v104
    v_lshl_or_b32 v116, v120, 9, v116
    v_lshl_or_b32 v104, v105, 18, v104
    ds_add_u32 v116, v3
    s_waitcnt vmcnt(0)
    v_lshl_or_b32 v105, v110, 16, v116
    s_mov_b64 exec, -1
    s_waitcnt lgkmcnt(0)
    s_barrier
    ds_read_b128 v[108:111], v1
    s_waitcnt lgkmcnt(0)
    v_lshrrev_b32 v108, 16, v108
    v_lshrrev_b32 v109, 16, v109
    v_lshrrev_b32 v110, 16, v110
    v_lshrrev_b32 v111, 16, v111
    v_add_u32 v112, v108, v109
    v_add3_u32 v112, v112, v110, v111
    v_mov_b32 v113, v112
    s_nop 0
    v_add_u32_dpp v112, v112, v112 row_shr:1 row_mask:0xf bank_mask:0xf bound_ctrl:0
    s_nop 1
    v_add_u32_dpp v112, v112, v112 row_shr:2 row_mask:0xf bank_mask:0xf bound_ctrl:0
    s_nop 1
    v_add_u32_dpp v112, v112, v112 row_shr:4 row_mask:0xf bank_mask:0xf bound_ctrl:0
    s_nop 1
    v_add_u32_dpp v112, v112, v112 row_shr:8 row_mask:0xf bank_mask:0xf bound_ctrl:0
    s_nop 1
    v_add_u32_dpp v112, v112, v112 row_bcast:15 row_mask:0xa bank_mask:0xf
    s_nop 1
    v_add_u32_dpp v112, v112, v112 row_bcast:31 row_mask:0xc bank_mask:0xf
    s_lshl_b32 s48, s44, 2
    v_mov_b32 v116, s48
    s_lshl_b64 exec, 1, 63
    ds_write_b32 v116, v112 offset:8192
    s_mov_b64 exec, -1
    v_sub_u32 v112, v112, v113
    v_and_b32 v120, 7, v0
    v_lshlrev_b32 v116, 2, v120
    v_and_b32 v122, 63, v0
    s_lshl_b32 s49, s44, 1
    v_lshl_add_u32 v122, v122, 6, s49
    v_mov_b32 v7, 1
    s_mov_b64 exec, 1
    ds_add_u32 v4, v7 offset:8244
    s_mov_b64 exec, -1
K1_QL2:
    ds_read_b32 v7, v4 offset:8244
    s_waitcnt lgkmcnt(0)
    v_readfirstlane_b32 s48, v7
    s_cmp_lt_u32 s48, 8
    s_cbranch_scc1 K1_QL2
    ds_read_b32 v121, v116 offset:8192
    v_cmp_gt_u32 vcc, s44, v120
    s_waitcnt lgkmcnt(0)
    s_nop 0
    v_cndmask_b32 v121, 0, v121, vcc
    s_nop 1
    v_add_u32_dpp v121, v121, v121 row_shr:1 row_mask:0xf bank_mask:0xf bound_ctrl:0
    s_nop 1
    v_add_u32_dpp v121, v121, v121 row_shr:2 row_mask:0xf bank_mask:0xf bound_ctrl:0
    s_nop 1
    v_add_u32_dpp v121, v121, v121 row_shr:4 row_mask:0xf bank_mask:0xf bound_ctrl:0
    s_nop 0
    v_readlane_b32 s51, v121, 7
    s_nop 1
    v_add_u32 v116, s51, v112
    v_add_u32 v117, v116, v108
    v_add_u32 v118, v117, v109
    v_add_u32 v119, v118, v110
    v_add_u32 v120, v119, v111
    v_mad_u32_u24 v108, v116, 6, s60
    v_mad_u32_u24 v109, v117, 6, s60
    v_mad_u32_u24 v110, v118, 6, s60
    v_mad_u32_u24 v111, v119, 6, s60
    ds_write_b128 v1, v[108:111]
    v_mov_b32 v3, 6
    ds_write_b16 v122, v116 offset:8320
    ds_write_b16 v122, v117 offset:8336
    ds_write_b16 v122, v118 offset:8352
    ds_write_b16 v122, v119 offset:8368
    ds_write_b16 v122, v120 offset:8384
    v_mov_b32 v7, 1
    s_mov_b64 exec, 1
    ds_add_u32 v4, v7 offset:8248
    s_mov_b64 exec, -1
K1_QL3:
    ds_read_b32 v7, v4 offset:8248
    s_waitcnt lgkmcnt(0)
    v_readfirstlane_b32 s48, v7
    s_cmp_lt_u32 s48, 8
    s_cbranch_scc1 K1_QL3
    v_and_b32 v106, 0xffff, v12
    v_and_b32 v107, 0xffff, v13
    v_and_b32 v108, 0xffff, v14
    v_and_b32 v109, 0xffff, v15
    ds_add_rtn_u32 v106, v106, v3
    ds_add_rtn_u32 v107, v107, v3
    ds_add_rtn_u32 v108, v108, v3
    ds_add_rtn_u32 v109, v109, v3
    v_and_b32 v110, 0xffff, v20
    v_and_b32 v111, 0xffff, v21
    v_and_b32 v112, 0xffff, v22
    v_and_b32 v113, 0xffff, v23
    ds_add_rtn_u32 v110, v110, v3
    ds_add_rtn_u32 v111, v111, v3
    ds_add_rtn_u32 v112, v112, v3
    ds_add_rtn_u32 v113, v113, v3
    s_waitcnt lgkmcnt(4)
    v_and_b32 v118, 2, v106
    v_add_u32 v114, v106, v118
    v_mad_i32_i24 v118, v118, -2, v106
    v_and_b32 v119, 2, v107
    v_add_u32 v115, v107, v119
    v_mad_i32_i24 v119, v119, -2, v107
    v_and_b32 v120, 2, v108
    v_add_u32 v116, v108, v120
    v_mad_i32_i24 v120, v120, -2, v108
    v_and_b32 v121, 2, v109
    v_add_u32 v117, v109, v121
    v_mad_i32_i24 v121, v121, -2, v109
    ds_write_b32 v114, v8
    ds_write_b16_d16_hi v118, v12 offset:4
    ds_write_b32 v115, v9
    ds_write_b16_d16_hi v119, v13 offset:4
    ds_write_b32 v116, v10
    ds_write_b16_d16_hi v120, v14 offset:4
    ds_write_b32 v117, v11
    ds_write_b16_d16_hi v121, v15 offset:4
    v_and_b32 v106, 0xffff, v28
    v_and_b32 v107, 0xffff, v29
    v_and_b32 v108, 0xffff, v30
    v_and_b32 v109, 0xffff, v31
    ds_add_rtn_u32 v106, v106, v3
    ds_add_rtn_u32 v107, v107, v3
    ds_add_rtn_u32 v108, v108, v3
    ds_add_rtn_u32 v109, v109, v3
    s_waitcnt lgkmcnt(12)
    v_and_b32 v118, 2, v110
    v_add_u32 v114, v110, v118
    v_mad_i32_i24 v118, v118, -2, v110
    v_and_b32 v119, 2, v111
    v_add_u32 v115, v111, v119
    v_mad_i32_i24 v119, v119, -2, v111
    v_and_b32 v120, 2, v112
    v_add_u32 v116, v112, v120
    v_mad_i32_i24 v120, v120, -2, v112
    v_and_b32 v121, 2, v113
    v_add_u32 v117, v113, v121
    v_mad_i32_i24 v121, v121, -2, v113
    ds_write_b32 v114, v16
    ds_write_b16_d16_hi v118, v20 offset:4
    ds_write_b32 v115, v17
    ds_write_b16_d16_hi v119, v21 offset:4
    ds_write_b32 v116, v18
    ds_write_b16_d16_hi v120, v22 offset:4
    ds_write_b32 v117, v19
    ds_write_b16_d16_hi v121, v23 offset:4
    v_and_b32 v110, 0xffff, v36
    v_and_b32 v111, 0xffff, v37
    v_and_b32 v112, 0xffff, v38
    v_and_b32 v113, 0xffff, v39
    ds_add_rtn_u32 v110, v110, v3
    ds_add_rtn_u32 v111, v111, v3
    ds_add_rtn_u32 v112, v112, v3
    ds_add_rtn_u32 v113, v113, v3
    s_waitcnt lgkmcnt(12)
    v_and_b32 v118, 2, v106
    v_add_u32 v114, v106, v118
    v_mad_i32_i24 v118, v118, -2, v106
    v_and_b32 v119, 2, v107
    v_add_u32 v115, v107, v119
    v_mad_i32_i24 v119, v119, -2, v107
    v_and_b32 v120, 2, v108
    v_add_u32 v116, v108, v120
    v_mad_i32_i24 v120, v120, -2, v108
    v_and_b32 v121, 2, v109
    v_add_u32 v117, v109, v121
    v_mad_i32_i24 v121, v121, -2, v109
    ds_write_b32 v114, v24
    ds_write_b16_d16_hi v118, v28 offset:4
    ds_write_b32 v115, v25
    ds_write_b16_d16_hi v119, v29 offset:4
    ds_write_b32 v116, v26
    ds_write_b16_d16_hi v120, v30 offset:4
    ds_write_b32 v117, v27
    ds_write_b16_d16_hi v121, v31 offset:4
    v_and_b32 v106, 0xffff, v44
    v_and_b32 v107, 0xffff, v45
    v_and_b32 v108, 0xffff, v46
    v_and_b32 v109, 0xffff, v47
    ds_add_rtn_u32 v106, v106, v3
    ds_add_rtn_u32 v107, v107, v3
    ds_add_rtn_u32 v108, v108, v3
    ds_add_rtn_u32 v109, v109, v3
    s_waitcnt lgkmcnt(12)
    v_and_b32 v118, 2, v110
    v_add_u32 v114, v110, v118
    v_mad_i32_i24 v118, v118, -2, v110
    v_and_b32 v119, 2, v111
    v_add_u32 v115, v111, v119
    v_mad_i32_i24 v119, v119, -2, v111
    v_and_b32 v120, 2, v112
    v_add_u32 v116, v112, v120
    v_mad_i32_i24 v120, v120, -2, v112
    v_and_b32 v121, 2, v113
    v_add_u32 v117, v113, v121
    v_mad_i32_i24 v121, v121, -2, v113
    ds_write_b32 v114, v32
    ds_write_b16_d16_hi v118, v36 offset:4
    ds_write_b32 v115, v33
    ds_write_b16_d16_hi v119, v37 offset:4
    ds_write_b32 v116, v34
    ds_write_b16_d16_hi v120, v38 offset:4
    ds_write_b32 v117, v35
    ds_write_b16_d16_hi v121, v39 offset:4
    v_and_b32 v110, 0xffff, v52
    v_and_b32 v111, 0xffff, v53
    v_and_b32 v112, 0xffff, v54
    v_and_b32 v113, 0xffff, v55
    ds_add_rtn_u32 v110, v110, v3
    ds_add_rtn_u32 v111, v111, v3
    ds_add_rtn_u32 v112, v112, v3
    ds_add_rtn_u32 v113, v113, v3
    s_waitcnt lgkmcnt(12)
    v_and_b32 v118, 2, v106
    v_add_u32 v114, v106, v118
    v_mad_i32_i24 v118, v118, -2, v106
    v_and_b32 v119, 2, v107
    v_add_u32 v115, v107, v119
    v_mad_i32_i24 v119, v119, -2, v107
    v_and_b32 v120, 2, v108
    v_add_u32 v116, v108, v120
    v_mad_i32_i24 v120, v120, -2, v108
    v_and_b32 v121, 2, v109
    v_add_u32 v117, v109, v121
    v_mad_i32_i24 v121, v121, -2, v109
    ds_write_b32 v114, v40
    ds_write_b16_d16_hi v118, v44 offset:4
    ds_write_b32 v115, v41
    ds_write_b16_d16_hi v119, v45 offset:4
    ds_write_b32 v116, v42
    ds_write_b16_d16_hi v120, v46 offset:4
    ds_write_b32 v117, v43
    ds_write_b16_d16_hi v121, v47 offset:4
    v_and_b32 v106, 0xffff, v60
    v_and_b32 v107, 0xffff, v61
    v_and_b32 v108, 0xffff, v62
    v_and_b32 v109, 0xffff, v63
    ds_add_rtn_u32 v106, v106, v3
    ds_add_rtn_u32 v107, v107, v3
    ds_add_rtn_u32 v108, v108, v3
    ds_add_rtn_u32 v109, v109, v3
    s_waitcnt lgkmcnt(12)
    v_and_b32 v118, 2, v110
    v_add_u32 v114, v110, v118
    v_mad_i32_i24 v118, v118, -2, v110
    v_and_b32 v119, 2, v111
    v_add_u32 v115, v111, v119
    v_mad_i32_i24 v119, v119, -2, v111
    v_and_b32 v120, 2, v112
    v_add_u32 v116, v112, v120
    v_mad_i32_i24 v120, v120, -2, v112
    v_and_b32 v121, 2, v113
    v_add_u32 v117, v113, v121
    v_mad_i32_i24 v121, v121, -2, v113
    ds_write_b32 v114, v48
    ds_write_b16_d16_hi v118, v52 offset:4
    ds_write_b32 v115, v49
    ds_write_b16_d16_hi v119, v53 offset:4
    ds_write_b32 v116, v50
    ds_write_b16_d16_hi v120, v54 offset:4
    ds_write_b32 v117, v51
    ds_write_b16_d16_hi v121, v55 offset:4
    v_and_b32 v110, 0xffff, v68
    v_and_b32 v111, 0xffff, v69
    v_and_b32 v112, 0xffff, v70
    v_and_b32 v113, 0xffff, v71
    ds_add_rtn_u32 v110, v110, v3
    ds_add_rtn_u32 v111, v111, v3
    ds_add_rtn_u32 v112, v112, v3
    ds_add_rtn_u32 v113, v113, v3
    s_waitcnt lgkmcnt(12)
    v_and_b32 v118, 2, v106
    v_add_u32 v114, v106, v118
    v_mad_i32_i24 v118, v118, -2, v106
    v_and_b32 v119, 2, v107
    v_add_u32 v115, v107, v119
    v_mad_i32_i24 v119, v119, -2, v107
    v_and_b32 v120, 2, v108
    v_add_u32 v116, v108, v120
    v_mad_i32_i24 v120, v120, -2, v108
    v_and_b32 v121, 2, v109
    v_add_u32 v117, v109, v121
    v_mad_i32_i24 v121, v121, -2, v109
    ds_write_b32 v114, v56
    ds_write_b16_d16_hi v118, v60 offset:4
    ds_write_b32 v115, v57
    ds_write_b16_d16_hi v119, v61 offset:4
    ds_write_b32 v116, v58
    ds_write_b16_d16_hi v120, v62 offset:4
    ds_write_b32 v117, v59
    ds_write_b16_d16_hi v121, v63 offset:4
    v_and_b32 v106, 0xffff, v76
    v_and_b32 v107, 0xffff, v77
    v_and_b32 v108, 0xffff, v78
    v_and_b32 v109, 0xffff, v79
    ds_add_rtn_u32 v106, v106, v3
    ds_add_rtn_u32 v107, v107, v3
    ds_add_rtn_u32 v108, v108, v3
    ds_add_rtn_u32 v109, v109, v3
    s_waitcnt lgkmcnt(12)
    v_and_b32 v118, 2, v110
    v_add_u32 v114, v110, v118
    v_mad_i32_i24 v118, v118, -2, v110
    v_and_b32 v119, 2, v111
    v_add_u32 v115, v111, v119
    v_mad_i32_i24 v119, v119, -2, v111
    v_and_b32 v120, 2, v112
    v_add_u32 v116, v112, v120
    v_mad_i32_i24 v120, v120, -2, v112
    v_and_b32 v121, 2, v113
    v_add_u32 v117, v113, v121
    v_mad_i32_i24 v121, v121, -2, v113
    ds_write_b32 v114, v64
    ds_write_b16_d16_hi v118, v68 offset:4
    ds_write_b32 v115, v65
    ds_write_b16_d16_hi v119, v69 offset:4
    ds_write_b32 v116, v66
    ds_write_b16_d16_hi v120, v70 offset:4
    ds_write_b32 v117, v67
    ds_write_b16_d16_hi v121, v71 offset:4
    v_and_b32 v110, 0xffff, v84
    v_and_b32 v111, 0xffff, v85
    v_and_b32 v112, 0xffff, v86
    v_and_b32 v113, 0xffff, v87
    ds_add_rtn_u32 v110, v110, v3
    ds_add_rtn_u32 v111, v111, v3
    ds_add_rtn_u32 v112, v112, v3
    ds_add_rtn_u32 v113, v113, v3
    s_waitcnt lgkmcnt(12)
    v_and_b32 v118, 2, v106
    v_add_u32 v114, v106, v118
    v_mad_i32_i24 v118, v118, -2, v106
    v_and_b32 v119, 2, v107
    v_add_u32 v115, v107, v119
    v_mad_i32_i24 v119, v119, -2, v107
    v_and_b32 v120, 2, v108
    v_add_u32 v116, v108, v120
    v_mad_i32_i24 v120, v120, -2, v108
    v_and_b32 v121, 2, v109
    v_add_u32 v117, v109, v121
    v_mad_i32_i24 v121, v121, -2, v109
    ds_write_b32 v114, v72
    ds_write_b16_d16_hi v118, v76 offset:4
    ds_write_b32 v115, v73
    ds_write_b16_d16_hi v119, v77 offset:4
    ds_write_b32 v116, v74
    ds_write_b16_d16_hi v120, v78 offset:4
    ds_write_b32 v117, v75
    ds_write_b16_d16_hi v121, v79 offset:4
    v_and_b32 v106, 0xffff, v92
    v_and_b32 v107, 0xffff, v93
    v_and_b32 v108, 0xffff, v94
    v_and_b32 v109, 0xffff, v95
    ds_add_rtn_u32 v106, v106, v3
    ds_add_rtn_u32 v107, v107, v3
    ds_add_rtn_u32 v108, v108, v3
    ds_add_rtn_u32 v109, v109, v3
    s_waitcnt lgkmcnt(12)
    v_and_b32 v118, 2, v110
    v_add_u32 v114, v110, v118
    v_mad_i32_i24 v118, v118, -2, v110
    v_and_b32 v119, 2, v111
    v_add_u32 v115, v111, v119
    v_mad_i32_i24 v119, v119, -2, v111
    v_and_b32 v120, 2, v112
    v_add_u32 v116, v112, v120
    v_mad_i32_i24 v120, v120, -2, v112
    v_and_b32 v121, 2, v113
    v_add_u32 v117, v113, v121
    v_mad_i32_i24 v121, v121, -2, v113
    ds_write_b32 v114, v80
    ds_write_b16_d16_hi v118, v84 offset:4
    ds_write_b32 v115, v81
    ds_write_b16_d16_hi v119, v85 offset:4
    ds_write_b32 v116, v82
    ds_write_b16_d16_hi v120, v86 offset:4
    ds_write_b32 v117, v83
    ds_write_b16_d16_hi v121, v87 offset:4
    v_and_b32 v110, 0xffff, v100
    v_and_b32 v111, 0xffff, v101
    v_and_b32 v112, 0xffff, v102
    v_and_b32 v113, 0xffff, v103
    ds_add_rtn_u32 v110, v110, v3
    ds_add_rtn_u32 v111, v111, v3
    ds_add_rtn_u32 v112, v112, v3
    ds_add_rtn_u32 v113, v113, v3
    s_waitcnt lgkmcnt(12)
    v_and_b32 v118, 2, v106
    v_add_u32 v114, v106, v118
    v_mad_i32_i24 v118, v118, -2, v106
    v_and_b32 v119, 2, v107
    v_add_u32 v115, v107, v119
    v_mad_i32_i24 v119, v119, -2, v107
    v_and_b32 v120, 2, v108
    v_add_u32 v116, v108, v120
    v_mad_i32_i24 v120, v120, -2, v108
    v_and_b32 v121, 2, v109
    v_add_u32 v117, v109, v121
    v_mad_i32_i24 v121, v121, -2, v109
    ds_write_b32 v114, v88
    ds_write_b16_d16_hi v118, v92 offset:4
    ds_write_b32 v115, v89
    ds_write_b16_d16_hi v119, v93 offset:4
    ds_write_b32 v116, v90
    ds_write_b16_d16_hi v120, v94 offset:4
    ds_write_b32 v117, v91
    ds_write_b16_d16_hi v121, v95 offset:4
    v_and_b32 v106, 0xffff, v105
    s_cmp_eq_u32 s58, 0
    s_cselect_b64 exec, -1, 0
    ds_add_rtn_u32 v106, v106, v3
    s_mov_b64 exec, -1
    s_waitcnt lgkmcnt(9)
    v_and_b32 v118, 2, v110
    v_add_u32 v114, v110, v118
    v_mad_i32_i24 v118, v118, -2, v110
    v_and_b32 v119, 2, v111
    v_add_u32 v115, v111, v119
    v_mad_i32_i24 v119, v119, -2, v111
    v_and_b32 v120, 2, v112
    v_add_u32 v116, v112, v120
    v_mad_i32_i24 v120, v120, -2, v112
    v_and_b32 v121, 2, v113
    v_add_u32 v117, v113, v121
    v_mad_i32_i24 v121, v121, -2, v113
    ds_write_b32 v114, v96
    ds_write_b16_d16_hi v118, v100 offset:4
    ds_write_b32 v115, v97
    ds_write_b16_d16_hi v119, v101 offset:4
    ds_write_b32 v116, v98
    ds_write_b16_d16_hi v120, v102 offset:4
    ds_write_b32 v117, v99
    ds_write_b16_d16_hi v121, v103 offset:4
    s_waitcnt lgkmcnt(8)
    v_and_b32 v118, 2, v106
    v_add_u32 v114, v106, v118
    v_mad_i32_i24 v118, v118, -2, v106
    s_cmp_eq_u32 s58, 0
    s_cselect_b64 exec, -1, 0
    ds_write_b32 v114, v104
    ds_write_b16_d16_hi v118, v105 offset:4
    s_mov_b64 exec, -1
    ds_read_b128 v[120:123], v1 offset:8320
    v_mov_b32 v7, 1
    s_mov_b64 exec, 1
    ds_add_u32 v4, v7 offset:8252
    s_mov_b64 exec, -1
K1_QL4:
    ds_read_b32 v7, v4 offset:8252
    s_waitcnt lgkmcnt(0)
    v_readfirstlane_b32 s48, v7
    s_cmp_lt_u32 s48, 8
    s_cbranch_scc1 K1_QL4
    v_cmp_gt_u32 vcc, 257, v0
    v_mov_b32 v5, s52
    s_nop 0
    v_cndmask_b32 v5, v5, v1, vcc
    buffer_store_dwordx4 v[120:123], v5, s[16:19], s57 offen sc1
    v_add_u32 v116, 12480, v1
    v_add_u32 v117, 78016, v1
    v_add_u32 v118, 143552, v1
    v_cmp_gt_u32 vcc, 168, v0
    v_mov_b32 v5, s52
    s_nop 0
    v_cndmask_b32 v5, v5, v1, vcc
    v_cndmask_b32 v6, v116, v118, vcc
    ds_read_b128 v[8:11], v116 offset:0
    ds_read_b128 v[12:15], v116 offset:8192
    ds_read_b128 v[16:19], v116 offset:16384
    ds_read_b128 v[20:23], v116 offset:24576
    ds_read_b128 v[24:27], v116 offset:32768
    ds_read_b128 v[28:31], v116 offset:40960
    ds_read_b128 v[32:35], v116 offset:49152
    ds_read_b128 v[36:39], v116 offset:57344
    ds_read_b128 v[40:43], v117 offset:0
    s_waitcnt lgkmcnt(8)
    s_add_u32 s50, s56, 0
    buffer_store_dwordx4 v[8:11], v1, s[16:19], s50 offen sc1
    ds_read_b128 v[44:47], v117 offset:8192
    s_waitcnt lgkmcnt(8)
    s_add_u32 s50, s56, 8192
    buffer_store_dwordx4 v[12:15], v1, s[16:19], s50 offen sc1
    ds_read_b128 v[48:51], v117 offset:16384
    s_waitcnt lgkmcnt(8)
    s_add_u32 s50, s56, 16384
    buffer_store_dwordx4 v[16:19], v1, s[16:19], s50 offen sc1
    ds_read_b128 v[52:55], v117 offset:24576
    s_waitcnt lgkmcnt(8)
    s_add_u32 s50, s56, 24576
    buffer_store_dwordx4 v[20:23], v1, s[16:19], s50 offen sc1
    ds_read_b128 v[56:59], v117 offset:32768
    s_waitcnt lgkmcnt(8)
    s_add_u32 s50, s56, 32768
    buffer_store_dwordx4 v[24:27], v1, s[16:19], s50 offen sc1
    ds_read_b128 v[60:63], v117 offset:40960
    s_waitcnt lgkmcnt(8)
    s_add_u32 s50, s56, 40960
    buffer_store_dwordx4 v[28:31], v1, s[16:19], s50 offen sc1
    ds_read_b128 v[64:67], v117 offset:49152
    s_waitcnt lgkmcnt(8)
    s_add_u32 s50, s56, 49152
    buffer_store_dwordx4 v[32:35], v1, s[16:19], s50 offen sc1
    ds_read_b128 v[68:71], v117 offset:57344
    s_waitcnt lgkmcnt(8)
    s_add_u32 s50, s56, 57344
    buffer_store_dwordx4 v[36:39], v1, s[16:19], s50 offen sc1
    ds_read_b128 v[72:75], v118 offset:0
    s_waitcnt lgkmcnt(8)
    s_add_u32 s50, s56, 65536
    buffer_store_dwordx4 v[40:43], v1, s[16:19], s50 offen sc1
    ds_read_b128 v[76:79], v118 offset:8192
    s_waitcnt lgkmcnt(8)
    s_add_u32 s50, s56, 73728
    buffer_store_dwordx4 v[44:47], v1, s[16:19], s50 offen sc1
    ds_read_b128 v[80:83], v6 offset:16384
    s_waitcnt lgkmcnt(8)
    s_add_u32 s50, s56, 81920
    buffer_store_dwordx4 v[48:51], v1, s[16:19], s50 offen sc1
    s_waitcnt lgkmcnt(7)
    s_add_u32 s50, s56, 90112
    buffer_store_dwordx4 v[52:55], v1, s[16:19], s50 offen sc1
    s_waitcnt lgkmcnt(6)
    s_add_u32 s50, s56, 98304
    buffer_store_dwordx4 v[56:59], v1, s[16:19], s50 offen sc1
    s_waitcnt lgkmcnt(5)
    s_add_u32 s50, s56, 106496
    buffer_store_dwordx4 v[60:63], v1, s[16:19], s50 offen sc1
    s_waitcnt lgkmcnt(4)
    s_add_u32 s50, s56, 114688
    buffer_store_dwordx4 v[64:67], v1, s[16:19], s50 offen sc1
    s_waitcnt lgkmcnt(3)
    s_add_u32 s50, s56, 122880
    buffer_store_dwordx4 v[68:71], v1, s[16:19], s50 offen sc1
    s_waitcnt lgkmcnt(2)
    s_add_u32 s50, s56, 131072
    buffer_store_dwordx4 v[72:75], v1, s[16:19], s50 offen sc1
    s_waitcnt lgkmcnt(1)
    s_add_u32 s50, s56, 139264
    buffer_store_dwordx4 v[76:79], v1, s[16:19], s50 offen sc1
    s_waitcnt lgkmcnt(0)
    s_add_u32 s50, s56, 147456
    buffer_store_dwordx4 v[80:83], v5, s[16:19], s50 offen sc1
K1_END:
    s_endpgm
.globl standalone__molecular_angular_gemnet__graph_kernel
.p2align 8
.type standalone__molecular_angular_gemnet__graph_kernel,@function
standalone__molecular_angular_gemnet__graph_kernel:
    s_cmp_ge_u32 s2, 256
    s_cbranch_scc1 K2_END
    s_load_dwordx2 s[4:5], s[0:1], 104
    s_mov_b32 s6, 268435456
    s_mov_b32 s7, 0x00020000
    v_lshrrev_b32 v100, 6, v0
    v_and_b32 v1, 63, v0
    v_readfirstlane_b32 s20, v100
    s_and_b32 s21, s2, 7
    s_lshl_b32 s21, s21, 5
    s_lshr_b32 s27, s2, 3
    s_or_b32 s21, s21, s27
    s_mov_b32 s31, 0xffff0000
    s_mov_b32 s33, 0x80000000
    v_mov_b32 v2, 0
    s_cmp_ge_u32 s20, 8
    s_cbranch_scc1 K2_CONS
    s_setprio 3
    s_mov_b32 s27, 150272
    v_mul_lo_u32 v4, v0, s27
    s_lshl_b32 s27, s21, 4
    v_mul_u32_u24 v101, 4224, v0
    v_add_u32 v101, s27, v101
    s_mov_b32 s27, 77594624
    s_waitcnt lgkmcnt(0)
    buffer_load_dwordx4 v[20:23], v101, s[4:7], s27 offen
    buffer_load_dwordx4 v[24:27], v101, s[4:7], s27 offen offset:16
    s_barrier
    v_mul_u32_u24 v3, 12, v1
    v_lshlrev_b32 v8, 4, v1
    v_mov_b32 v7, 4
    v_min_u32 v5, 1, v1
    v_lshlrev_b32 v6, 3, v0
    v_add_u32 v6, 151808, v6
    v_mov_b32 v102, 0
    v_mov_b32 v103, 0
    ds_write_b64 v6, v[102:103]
    s_mov_b32 s37, 0
    s_mov_b32 s36, 0
    s_lshl_b32 s39, s21, 15
    s_add_u32 s39, s39, 90177536
    v_mov_b32 v88, -1
    v_mov_b32 v89, -1
    v_mov_b32 v90, -1
    v_mov_b32 v91, -1
    v_lshlrev_b32 v92, 4, v0
    v_mov_b32 v82, 0
    v_mov_b32 v83, 0
    v_mov_b32 v84, 0
    v_mov_b32 v85, 0
    s_mov_b32 s22, 8
    s_mov_b32 s23, 0
    s_mov_b32 s27, 0x05040100
    s_mov_b32 s28, 0x07060302
    s_waitcnt vmcnt(0) lgkmcnt(0)
    v_perm_b32 v10, v24, v20, s27
    v_perm_b32 v11, v24, v20, s28
    v_perm_b32 v12, v25, v21, s27
    v_perm_b32 v13, v25, v21, s28
    v_perm_b32 v14, v26, v22, s27
    v_perm_b32 v15, v26, v22, s28
    v_perm_b32 v16, v27, v23, s27
    v_perm_b32 v17, v27, v23, s28
K2_PLOOP:
    v_and_b32 v100, 0xffff, v10
    v_lshrrev_b32 v101, 16, v10
    v_lshrrev_b32 v102, 1, v100
    v_add_u32 v103, 1, v101
    v_cmp_gt_u32 s[34:35], v101, v100
    v_lshrrev_b32 v103, 1, v103
    v_sub_u32 v103, v103, v102
    v_cndmask_b32 v103, 0, v103, s[34:35]
    v_mov_b32 v104, v103
    s_nop 1
    v_add_u32_dpp v104, v104, v104 row_shr:1 row_mask:0xf bank_mask:0xf bound_ctrl:0
    s_nop 1
    v_add_u32_dpp v104, v104, v104 row_shr:2 row_mask:0xf bank_mask:0xf bound_ctrl:0
    s_nop 1
    v_add_u32_dpp v104, v104, v104 row_shr:4 row_mask:0xf bank_mask:0xf bound_ctrl:0
    s_nop 1
    v_add_u32_dpp v104, v104, v104 row_shr:8 row_mask:0xf bank_mask:0xf bound_ctrl:0
    s_nop 1
    v_add_u32_dpp v104, v104, v104 row_bcast:15 row_mask:0xa bank_mask:0xf
    s_nop 1
    v_add_u32_dpp v104, v104, v104 row_bcast:31 row_mask:0xc bank_mask:0xf
    s_nop 0
    v_readlane_b32 s24, v104, 63
    s_cmp_lt_u32 s23, s24
    s_cbranch_scc1 K2_FGO
    s_cmp_eq_u32 s22, 0
    s_cbranch_scc1 K2_FGO
    v_mov_b32 v10, v11
    v_mov_b32 v11, v12
    v_mov_b32 v12, v13
    v_mov_b32 v13, v14
    v_mov_b32 v14, v15
    v_mov_b32 v15, v16
    v_mov_b32 v16, v17
    v_mov_b32 v17, 0
    s_sub_u32 s22, s22, 1
    s_mov_b32 s23, 0
    s_branch K2_PLOOP
K2_FGO:
    v_subrev_u32 v104, s23, v104
    v_sub_u32 v105, v104, v103
    v_add_u32 v110, -1, v104
    v_sub_u32 v106, v102, v105
    v_mad_i32_i24 v106, v106, 12, v4
    v_cmp_le_i32 vcc, 0, v105
    v_and_b32 v107, 1, v100
    s_and_b64 vcc, vcc, s[34:35]
    v_max_i32 v108, 0, v105
    v_cndmask_b32 v107, 0, v107, vcc
    v_lshl_or_b32 v107, v107, 6, v5
    v_and_b32 v109, 1, v101
    v_lshlrev_b32 v109, 7, v109
    v_lshrrev_b32 v100, 3, v108
    v_and_b32 v100, 0x18, v100
    v_lshlrev_b32 v107, v100, v107
    v_lshrrev_b32 v100, 8, v108
    v_cmp_gt_u32 vcc, 512, v108
    v_and_b32 v108, 63, v108
    v_sub_u32 v108, v108, v1
    v_lshl_add_u32 v108, v108, 1, v100
    v_lshl_add_u32 v108, v108, 2, v6
    s_mov_b64 exec, vcc
    ds_add_u32 v108, v107
    s_mov_b64 exec, -1
    v_lshrrev_b32 v100, 3, v110
    v_and_b32 v100, 0x18, v100
    v_lshlrev_b32 v109, v100, v109
    v_lshrrev_b32 v100, 8, v110
    v_cmp_gt_u32 vcc, 512, v110
    v_and_b32 v110, 63, v110
    v_sub_u32 v110, v110, v1
    v_lshl_add_u32 v110, v110, 1, v100
    v_lshl_add_u32 v110, v110, 2, v6
    s_and_b64 exec, vcc, s[34:35]
    ds_add_u32 v110, v109
    s_mov_b64 exec, -1
    ds_read_b64 v[112:113], v6
    v_mov_b32 v114, 0
    v_mov_b32 v115, 0
    ds_write_b64 v6, v[114:115]
    s_sub_u32 s29, s24, s23
    s_waitcnt lgkmcnt(1)
    v_and_b32 v116, 0x3f3f3f3f, v112
    v_and_b32 v117, 0x3f3f3f3f, v113
    v_lshlrev_b32 v114, 1, v112
    v_lshlrev_b32 v115, 1, v113
    v_add_u32_dpp v116, v116, v116 row_shr:1 row_mask:0xf bank_mask:0xf bound_ctrl:0
    v_add_u32_dpp v117, v117, v117 row_shr:1 row_mask:0xf bank_mask:0xf bound_ctrl:0
    v_cmp_le_i32_sdwa s[40:41], 0, sext(v114) src0_sel:DWORD src1_sel:BYTE_0
    v_add_u32_dpp v116, v116, v116 row_shr:2 row_mask:0xf bank_mask:0xf bound_ctrl:0
    v_add_u32_dpp v117, v117, v117 row_shr:2 row_mask:0xf bank_mask:0xf bound_ctrl:0
    v_cmp_le_i32_sdwa s[42:43], 0, sext(v112) src0_sel:DWORD src1_sel:BYTE_0
    v_add_u32_dpp v116, v116, v116 row_shr:4 row_mask:0xf bank_mask:0xf bound_ctrl:0
    v_add_u32_dpp v117, v117, v117 row_shr:4 row_mask:0xf bank_mask:0xf bound_ctrl:0
    v_cmp_le_i32_sdwa s[44:45], 0, sext(v114) src0_sel:DWORD src1_sel:BYTE_1
    v_add_u32_dpp v116, v116, v116 row_shr:8 row_mask:0xf bank_mask:0xf bound_ctrl:0
    v_add_u32_dpp v117, v117, v117 row_shr:8 row_mask:0xf bank_mask:0xf bound_ctrl:0
    v_cmp_le_i32_sdwa s[46:47], 0, sext(v112) src0_sel:DWORD src1_sel:BYTE_1
    v_add_u32_dpp v116, v116, v116 row_bcast:15 row_mask:0xa bank_mask:0xf
    v_add_u32_dpp v117, v117, v117 row_bcast:15 row_mask:0xa bank_mask:0xf
    v_cmp_le_i32_sdwa s[48:49], 0, sext(v114) src0_sel:DWORD src1_sel:BYTE_2
    v_add_u32_dpp v116, v116, v116 row_bcast:31 row_mask:0xc bank_mask:0xf
    v_add_u32_dpp v117, v117, v117 row_bcast:31 row_mask:0xc bank_mask:0xf
    v_cmp_le_i32_sdwa s[50:51], 0, sext(v112) src0_sel:DWORD src1_sel:BYTE_2
    v_readlane_b32 s27, v116, 63
    v_readlane_b32 s28, v117, 63
    v_cmp_le_i32_sdwa s[52:53], 0, sext(v114) src0_sel:DWORD src1_sel:BYTE_3
    v_cmp_le_i32_sdwa s[54:55], 0, sext(v112) src0_sel:DWORD src1_sel:BYTE_3
    s_mul_i32 s34, s27, 0x01010101
    s_lshl_b32 s27, s34, 8
    s_lshr_b32 s34, s34, 24
    s_lshl_b32 s28, s28, 8
    s_add_u32 s28, s28, s34
    s_mul_i32 s28, s28, 0x01010101
    v_add_u32 v116, s27, v116
    v_add_u32 v117, s28, v117
    v_lshlrev_b32_sdwa v118, 2, v116 dst_sel:DWORD dst_unused:UNUSED_PAD src0_sel:DWORD src1_sel:BYTE_0
    ds_bpermute_b32 v118, v118, v106
    v_lshlrev_b32_sdwa v119, 2, v116 dst_sel:DWORD dst_unused:UNUSED_PAD src0_sel:DWORD src1_sel:BYTE_1
    ds_bpermute_b32 v119, v119, v106
    v_lshlrev_b32_sdwa v120, 2, v116 dst_sel:DWORD dst_unused:UNUSED_PAD src0_sel:DWORD src1_sel:BYTE_2
    ds_bpermute_b32 v120, v120, v106
    v_lshlrev_b32_sdwa v121, 2, v116 dst_sel:DWORD dst_unused:UNUSED_PAD src0_sel:DWORD src1_sel:BYTE_3
    ds_bpermute_b32 v121, v121, v106
    v_lshlrev_b32_sdwa v122, 2, v117 dst_sel:DWORD dst_unused:UNUSED_PAD src0_sel:DWORD src1_sel:BYTE_0
    ds_bpermute_b32 v122, v122, v106
    v_lshlrev_b32_sdwa v123, 2, v117 dst_sel:DWORD dst_unused:UNUSED_PAD src0_sel:DWORD src1_sel:BYTE_1
    ds_bpermute_b32 v123, v123, v106
    v_lshlrev_b32_sdwa v124, 2, v117 dst_sel:DWORD dst_unused:UNUSED_PAD src0_sel:DWORD src1_sel:BYTE_2
    ds_bpermute_b32 v124, v124, v106
    v_lshlrev_b32_sdwa v125, 2, v117 dst_sel:DWORD dst_unused:UNUSED_PAD src0_sel:DWORD src1_sel:BYTE_3
    ds_bpermute_b32 v125, v125, v106
    v_cmp_le_i32_sdwa s[56:57], 0, sext(v115) src0_sel:DWORD src1_sel:BYTE_0
    v_cmp_le_i32_sdwa s[58:59], 0, sext(v113) src0_sel:DWORD src1_sel:BYTE_0
    v_cmp_le_i32_sdwa s[60:61], 0, sext(v115) src0_sel:DWORD src1_sel:BYTE_1
    v_cmp_le_i32_sdwa s[62:63], 0, sext(v113) src0_sel:DWORD src1_sel:BYTE_1
    v_cmp_le_i32_sdwa s[64:65], 0, sext(v115) src0_sel:DWORD src1_sel:BYTE_2
    v_cmp_le_i32_sdwa s[66:67], 0, sext(v113) src0_sel:DWORD src1_sel:BYTE_2
    v_cmp_le_i32_sdwa s[68:69], 0, sext(v115) src0_sel:DWORD src1_sel:BYTE_3
    v_cmp_le_i32_sdwa s[70:71], 0, sext(v113) src0_sel:DWORD src1_sel:BYTE_3
    v_mov_b32 v100, s33
    v_add_u32 v101, 3072, v3
    v_cmp_gt_i32 vcc, s29, v1
    s_sub_u32 s29, s29, 64
    s_and_b64 s[40:41], s[40:41], vcc
    s_and_b64 s[42:43], s[42:43], vcc
    s_waitcnt lgkmcnt(7)
    v_add_u32 v118, v118, v3
    v_cndmask_b32 v118, v100, v118, vcc
    buffer_load_dwordx3 v[18:20], v118, s[4:7], 0 offen offset:0
    v_cmp_gt_i32 vcc, s29, v1
    s_sub_u32 s29, s29, 64
    s_and_b64 s[44:45], s[44:45], vcc
    s_and_b64 s[46:47], s[46:47], vcc
    s_waitcnt lgkmcnt(6)
    v_add_u32 v119, v119, v3
    v_cndmask_b32 v119, v100, v119, vcc
    buffer_load_dwordx3 v[22:24], v119, s[4:7], 0 offen offset:768
    v_cmp_gt_i32 vcc, s29, v1
    s_sub_u32 s29, s29, 64
    s_and_b64 s[48:49], s[48:49], vcc
    s_and_b64 s[50:51], s[50:51], vcc
    s_waitcnt lgkmcnt(5)
    v_add_u32 v120, v120, v3
    v_cndmask_b32 v120, v100, v120, vcc
    buffer_load_dwordx3 v[26:28], v120, s[4:7], 0 offen offset:1536
    v_cmp_gt_i32 vcc, s29, v1
    s_sub_u32 s29, s29, 64
    s_and_b64 s[52:53], s[52:53], vcc
    s_and_b64 s[54:55], s[54:55], vcc
    s_waitcnt lgkmcnt(4)
    v_add_u32 v121, v121, v3
    v_cndmask_b32 v121, v100, v121, vcc
    buffer_load_dwordx3 v[30:32], v121, s[4:7], 0 offen offset:2304
    v_cmp_gt_i32 vcc, s29, v1
    s_sub_u32 s29, s29, 64
    s_and_b64 s[56:57], s[56:57], vcc
    s_and_b64 s[58:59], s[58:59], vcc
    s_waitcnt lgkmcnt(3)
    v_add_u32 v122, v122, v101
    v_cndmask_b32 v122, v100, v122, vcc
    buffer_load_dwordx3 v[34:36], v122, s[4:7], 0 offen offset:0
    v_cmp_gt_i32 vcc, s29, v1
    s_sub_u32 s29, s29, 64
    s_and_b64 s[60:61], s[60:61], vcc
    s_and_b64 s[62:63], s[62:63], vcc
    s_waitcnt lgkmcnt(2)
    v_add_u32 v123, v123, v101
    v_cndmask_b32 v123, v100, v123, vcc
    buffer_load_dwordx3 v[38:40], v123, s[4:7], 0 offen offset:768
    v_cmp_gt_i32 vcc, s29, v1
    s_sub_u32 s29, s29, 64
    s_and_b64 s[64:65], s[64:65], vcc
    s_and_b64 s[66:67], s[66:67], vcc
    s_waitcnt lgkmcnt(1)
    v_add_u32 v124, v124, v101
    v_cndmask_b32 v124, v100, v124, vcc
    buffer_load_dwordx3 v[42:44], v124, s[4:7], 0 offen offset:1536
    v_cmp_gt_i32 vcc, s29, v1
    s_sub_u32 s29, s29, 64
    s_and_b64 s[68:69], s[68:69], vcc
    s_and_b64 s[70:71], s[70:71], vcc
    s_waitcnt lgkmcnt(0)
    v_add_u32 v125, v125, v101
    v_cndmask_b32 v125, v100, v125, vcc
    buffer_load_dwordx3 v[46:48], v125, s[4:7], 0 offen offset:2304
    s_add_u32 s23, s23, 512
    s_cmp_lt_u32 s23, s24
    s_cbranch_scc1 K2_FDONE
    s_mov_b32 s23, 0
    s_cmp_eq_u32 s22, 0
    s_cbranch_scc1 K2_FDONE
    v_mov_b32 v10, v11
    v_mov_b32 v11, v12
    v_mov_b32 v12, v13
    v_mov_b32 v13, v14
    v_mov_b32 v14, v15
    v_mov_b32 v15, v16
    v_mov_b32 v16, v17
    v_mov_b32 v17, 0
    s_sub_u32 s22, s22, 1
K2_FDONE:
K2_PL1:
    ds_read_b32 v86, v2 offset:2096
    s_waitcnt lgkmcnt(0)
    v_readfirstlane_b32 s27, v86
    s_cmp_lt_u32 s27, s37
    s_cbranch_scc1 K2_PL1
    s_add_u32 s37, s37, 32
    s_cmp_lt_u32 s36, 0xff00
    s_cselect_b32 s38, s37, s38
    s_cmp_le_u32 s22, 0
    s_cselect_b32 s27, 0x100, 0
    s_cmp_eq_u32 s22, 0
    s_addc_u32 s27, s27, 0
    s_lshl_b32 s27, s27, s20
    v_mov_b32 v86, s27
    s_waitcnt vmcnt(7)
    v_lshlrev_b32_sdwa v66, 2, v18 dst_sel:DWORD dst_unused:UNUSED_PAD src0_sel:DWORD src1_sel:BYTE_1
    v_lshlrev_b32_sdwa v67, 2, v20 dst_sel:DWORD dst_unused:UNUSED_PAD src0_sel:DWORD src1_sel:BYTE_1
    s_mov_b64 exec, s[40:41]
    ds_add_rtn_u32 v50, v66, v7
    s_mov_b64 exec, s[42:43]
    ds_add_rtn_u32 v51, v67, v7
    s_mov_b64 exec, -1
    s_waitcnt vmcnt(6)
    v_lshlrev_b32_sdwa v68, 2, v22 dst_sel:DWORD dst_unused:UNUSED_PAD src0_sel:DWORD src1_sel:BYTE_1
    v_lshlrev_b32_sdwa v69, 2, v24 dst_sel:DWORD dst_unused:UNUSED_PAD src0_sel:DWORD src1_sel:BYTE_1
    s_mov_b64 exec, s[44:45]
    ds_add_rtn_u32 v52, v68, v7
    s_mov_b64 exec, s[46:47]
    ds_add_rtn_u32 v53, v69, v7
    s_mov_b64 exec, -1
    s_waitcnt vmcnt(5)
    v_lshlrev_b32_sdwa v70, 2, v26 dst_sel:DWORD dst_unused:UNUSED_PAD src0_sel:DWORD src1_sel:BYTE_1
    v_lshlrev_b32_sdwa v71, 2, v28 dst_sel:DWORD dst_unused:UNUSED_PAD src0_sel:DWORD src1_sel:BYTE_1
    s_mov_b64 exec, s[48:49]
    ds_add_rtn_u32 v54, v70, v7
    s_mov_b64 exec, s[50:51]
    ds_add_rtn_u32 v55, v71, v7
    s_mov_b64 exec, -1
    s_waitcnt vmcnt(4)
    v_lshlrev_b32_sdwa v72, 2, v30 dst_sel:DWORD dst_unused:UNUSED_PAD src0_sel:DWORD src1_sel:BYTE_1
    v_lshlrev_b32_sdwa v73, 2, v32 dst_sel:DWORD dst_unused:UNUSED_PAD src0_sel:DWORD src1_sel:BYTE_1
    s_mov_b64 exec, s[52:53]
    ds_add_rtn_u32 v56, v72, v7
    s_mov_b64 exec, s[54:55]
    ds_add_rtn_u32 v57, v73, v7
    s_mov_b64 exec, -1
    s_waitcnt vmcnt(3)
    v_lshlrev_b32_sdwa v74, 2, v34 dst_sel:DWORD dst_unused:UNUSED_PAD src0_sel:DWORD src1_sel:BYTE_1
    v_lshlrev_b32_sdwa v75, 2, v36 dst_sel:DWORD dst_unused:UNUSED_PAD src0_sel:DWORD src1_sel:BYTE_1
    s_mov_b64 exec, s[56:57]
    ds_add_rtn_u32 v58, v74, v7
    s_mov_b64 exec, s[58:59]
    ds_add_rtn_u32 v59, v75, v7
    s_mov_b64 exec, -1
    s_waitcnt vmcnt(2)
    v_lshlrev_b32_sdwa v76, 2, v38 dst_sel:DWORD dst_unused:UNUSED_PAD src0_sel:DWORD src1_sel:BYTE_1
    v_lshlrev_b32_sdwa v77, 2, v40 dst_sel:DWORD dst_unused:UNUSED_PAD src0_sel:DWORD src1_sel:BYTE_1
    s_mov_b64 exec, s[60:61]
    ds_add_rtn_u32 v60, v76, v7
    s_mov_b64 exec, s[62:63]
    ds_add_rtn_u32 v61, v77, v7
    s_mov_b64 exec, -1
    s_waitcnt vmcnt(1)
    v_lshlrev_b32_sdwa v78, 2, v42 dst_sel:DWORD dst_unused:UNUSED_PAD src0_sel:DWORD src1_sel:BYTE_1
    v_lshlrev_b32_sdwa v79, 2, v44 dst_sel:DWORD dst_unused:UNUSED_PAD src0_sel:DWORD src1_sel:BYTE_1
    s_mov_b64 exec, s[64:65]
    ds_add_rtn_u32 v62, v78, v7
    s_mov_b64 exec, s[66:67]
    ds_add_rtn_u32 v63, v79, v7
    s_mov_b64 exec, -1
    s_waitcnt vmcnt(0)
    v_lshlrev_b32_sdwa v80, 2, v46 dst_sel:DWORD dst_unused:UNUSED_PAD src0_sel:DWORD src1_sel:BYTE_1
    v_lshlrev_b32_sdwa v81, 2, v48 dst_sel:DWORD dst_unused:UNUSED_PAD src0_sel:DWORD src1_sel:BYTE_1
    s_mov_b64 exec, s[68:69]
    ds_add_rtn_u32 v64, v80, v7
    s_mov_b64 exec, s[70:71]
    ds_add_rtn_u32 v65, v81, v7
    s_mov_b64 exec, 1
    ds_or_b32 v2, v86 offset:2092
    ds_add_u32 v2, v7 offset:2088
    s_mov_b64 exec, -1
    s_and_b32 s27, s39, 0x6000
    s_cmp_eq_u32 s27, 0x6000
    s_cbranch_scc1 K2_PLH
    buffer_store_dwordx4 v[88:91], v92, s[4:7], s39 offen sc1
    s_add_u32 s39, s39, 8192
K2_PLH:
    ds_read_b64 v[86:87], v2 offset:2088
    s_waitcnt lgkmcnt(0)
    v_readfirstlane_b32 s27, v86
    s_cmp_lt_u32 s27, s37
    s_cbranch_scc1 K2_PLH
    s_setprio 0
    ds_read_b128 v[100:103], v8
    s_mov_b64 exec, 1
    ds_add_u32 v2, v7 offset:2096
    s_mov_b64 exec, -1
    v_readfirstlane_b32 s36, v87
    s_waitcnt lgkmcnt(1)
    v_sub_u32 v104, v100, v82
    v_sub_u32 v105, v101, v83
    v_sub_u32 v106, v102, v84
    v_sub_u32 v107, v103, v85
    v_add_u32 v108, v104, v105
    v_add3_u32 v108, v108, v106, v107
    v_sub_u32 v109, 118784, v108
    s_nop 0
    v_add_u32_dpp v108, v108, v108 row_shr:1 row_mask:0xf bank_mask:0xf bound_ctrl:0
    s_nop 1
    v_add_u32_dpp v108, v108, v108 row_shr:2 row_mask:0xf bank_mask:0xf bound_ctrl:0
    s_nop 1
    v_add_u32_dpp v108, v108, v108 row_shr:4 row_mask:0xf bank_mask:0xf bound_ctrl:0
    s_nop 1
    v_add_u32_dpp v108, v108, v108 row_shr:8 row_mask:0xf bank_mask:0xf bound_ctrl:0
    s_nop 1
    v_add_u32_dpp v108, v108, v108 row_bcast:15 row_mask:0xa bank_mask:0xf
    s_nop 1
    v_add_u32_dpp v108, v108, v108 row_bcast:31 row_mask:0xc bank_mask:0xf
    v_add_u32 v109, v109, v108
    v_readlane_b32 s25, v108, 63
    v_sub_u32 v112, v109, v82
    v_add_u32 v109, v109, v104
    v_mov_b32 v82, v100
    v_sub_u32 v113, v109, v83
    v_add_u32 v109, v109, v105
    v_mov_b32 v83, v101
    v_sub_u32 v114, v109, v84
    v_add_u32 v109, v109, v106
    v_mov_b32 v84, v102
    v_sub_u32 v115, v109, v85
    v_mov_b32 v85, v103
    ds_write_b128 v8, v[112:115] offset:1024
    ds_read_b32 v66, v66 offset:1024
    ds_read_b32 v67, v67 offset:1024
    ds_read_b32 v68, v68 offset:1024
    ds_read_b32 v69, v69 offset:1024
    ds_read_b32 v70, v70 offset:1024
    ds_read_b32 v71, v71 offset:1024
    ds_read_b32 v72, v72 offset:1024
    ds_read_b32 v73, v73 offset:1024
    ds_read_b32 v74, v74 offset:1024
    ds_read_b32 v75, v75 offset:1024
    ds_read_b32 v76, v76 offset:1024
    ds_read_b32 v77, v77 offset:1024
    ds_read_b32 v78, v78 offset:1024
    ds_read_b32 v79, v79 offset:1024
    ds_read_b32 v80, v80 offset:1024
    ds_read_b32 v81, v81 offset:1024
    s_sub_u32 s28, s37, 32
K2_PL2:
    ds_read_b32 v86, v2 offset:2100
    s_waitcnt lgkmcnt(0)
    v_readfirstlane_b32 s27, v86
    s_cmp_lt_u32 s27, s28
    s_cbranch_scc1 K2_PL2
    s_cmp_lg_u32 s20, 0
    s_cbranch_scc1 K2_NOPAD
    s_add_u32 s27, s25, 118784
    v_lshl_add_u32 v108, v1, 2, s27
    v_mov_b32 v109, 0xc357ffff
    ds_write_b32 v108, v109
    v_lshrrev_b32 v108, 1, v108
    v_cmp_gt_u32 vcc, 75776, v108
    s_cmp_eq_u32 s36, 0xffff
    s_addc_u32 s27, s25, 0
    v_mov_b32 v111, s27
    ds_write_b32 v2, v111 offset:2084
    s_mov_b64 exec, vcc
    ds_write_b16 v108, v2 offset:43008
    s_mov_b64 exec, -1
K2_NOPAD:
    v_add_u32 v50, v50, v66
    v_lshrrev_b32 v66, 1, v50
    v_add_u32 v51, v51, v67
    v_lshrrev_b32 v67, 1, v51
    v_add_u32 v52, v52, v68
    v_lshrrev_b32 v68, 1, v52
    v_add_u32 v53, v53, v69
    v_lshrrev_b32 v69, 1, v53
    v_add_u32 v54, v54, v70
    v_lshrrev_b32 v70, 1, v54
    v_add_u32 v55, v55, v71
    v_lshrrev_b32 v71, 1, v55
    v_add_u32 v56, v56, v72
    v_lshrrev_b32 v72, 1, v56
    v_add_u32 v57, v57, v73
    v_lshrrev_b32 v73, 1, v57
    v_add_u32 v58, v58, v74
    v_lshrrev_b32 v74, 1, v58
    v_add_u32 v59, v59, v75
    v_lshrrev_b32 v75, 1, v59
    v_add_u32 v60, v60, v76
    v_lshrrev_b32 v76, 1, v60
    v_add_u32 v61, v61, v77
    v_lshrrev_b32 v77, 1, v61
    v_add_u32 v62, v62, v78
    v_lshrrev_b32 v78, 1, v62
    v_add_u32 v63, v63, v79
    v_lshrrev_b32 v79, 1, v63
    v_add_u32 v64, v64, v80
    v_lshrrev_b32 v80, 1, v64
    v_add_u32 v65, v65, v81
    v_lshrrev_b32 v81, 1, v65
    s_mov_b64 exec, s[40:41]
    ds_write_b32 v50, v18
    ds_write_b16 v66, v19 offset:43008
    s_mov_b64 exec, s[42:43]
    ds_write_b32 v51, v20
    ds_write_b16_d16_hi v67, v19 offset:43008
    s_mov_b64 exec, s[44:45]
    ds_write_b32 v52, v22
    ds_write_b16 v68, v23 offset:43008
    s_mov_b64 exec, s[46:47]
    ds_write_b32 v53, v24
    ds_write_b16_d16_hi v69, v23 offset:43008
    s_mov_b64 exec, s[48:49]
    ds_write_b32 v54, v26
    ds_write_b16 v70, v27 offset:43008
    s_mov_b64 exec, s[50:51]
    ds_write_b32 v55, v28
    ds_write_b16_d16_hi v71, v27 offset:43008
    s_mov_b64 exec, s[52:53]
    ds_write_b32 v56, v30
    ds_write_b16 v72, v31 offset:43008
    s_mov_b64 exec, s[54:55]
    ds_write_b32 v57, v32
    ds_write_b16_d16_hi v73, v31 offset:43008
    s_mov_b64 exec, s[56:57]
    ds_write_b32 v58, v34
    ds_write_b16 v74, v35 offset:43008
    s_mov_b64 exec, s[58:59]
    ds_write_b32 v59, v36
    ds_write_b16_d16_hi v75, v35 offset:43008
    s_mov_b64 exec, s[60:61]
    ds_write_b32 v60, v38
    ds_write_b16 v76, v39 offset:43008
    s_mov_b64 exec, s[62:63]
    ds_write_b32 v61, v40
    ds_write_b16_d16_hi v77, v39 offset:43008
    s_mov_b64 exec, s[64:65]
    ds_write_b32 v62, v42
    ds_write_b16 v78, v43 offset:43008
    s_mov_b64 exec, s[66:67]
    ds_write_b32 v63, v44
    ds_write_b16_d16_hi v79, v43 offset:43008
    s_mov_b64 exec, s[68:69]
    ds_write_b32 v64, v46
    ds_write_b16 v80, v47 offset:43008
    s_mov_b64 exec, s[70:71]
    ds_write_b32 v65, v48
    ds_write_b16_d16_hi v81, v47 offset:43008
    s_mov_b64 exec, 1
    ds_add_u32 v2, v7 offset:2080
    s_mov_b64 exec, -1
    s_setprio 3
    s_cmp_lg_u32 s36, 0xffff
    s_cbranch_scc1 K2_PLOOP
K2_PTAIL:
    s_setprio 3
    s_load_dwordx2 s[60:61], s[0:1], 24
    s_load_dwordx2 s[56:57], s[0:1], 56
    s_load_dwordx2 s[52:53], s[0:1], 64
    s_load_dwordx2 s[64:65], s[0:1], 0
    s_load_dwordx2 s[72:73], s[0:1], 80
    s_load_dwordx2 s[16:17], s[0:1], 88
    s_mov_b32 s62, 1600000
    s_mov_b32 s63, 0x00020000
    s_mov_b32 s54, 128
    s_mov_b32 s55, 0x00020000
    s_mov_b32 s58, 64
    s_mov_b32 s59, 0x00020000
    s_mov_b32 s66, 6400000
    s_mov_b32 s67, 0x00020000
    s_mov_b32 s18, 6400000
    s_mov_b32 s19, 0x00020000
    s_lshr_b32 s27, s21, 7
    s_and_b32 s28, s21, 127
    s_mul_i32 s22, s27, 3125
    s_sub_u32 s23, 3125, s22
    s_mul_i32 s28, s28, 6250
    s_lshl_b32 s24, s28, 3
    s_add_u32 s28, s28, s23
    s_mul_i32 s36, s21, 32768
    s_add_u32 s36, s36, 90177536
    s_xor_b32 s29, s21, 128
    s_mul_i32 s38, s29, 32768
    s_add_u32 s38, s38, 90177536
    s_mov_b32 s33, 0x80008000
    v_cmp_gt_u32 s[70:71], 53, v0
    v_mov_b32 v88, -1
    v_mov_b32 v89, -1
    v_mov_b32 v90, -1
    v_mov_b32 v91, -1
    v_lshlrev_b32 v6, 4, v0
K2_PZ0:
    s_and_b32 s27, s39, 0x6000
    s_cmp_eq_u32 s27, 0x6000
    s_cbranch_scc1 K2_PZ1
    buffer_store_dwordx4 v[88:91], v92, s[4:7], s39 offen sc1
    s_add_u32 s39, s39, 8192
    s_branch K2_PZ0
K2_PZ1:
    s_add_u32 s27, s36, 24576
    s_mov_b64 exec, s[70:71]
    buffer_store_dwordx4 v[88:91], v6, s[4:7], s27 offen sc1
    s_mov_b64 exec, -1
K2_PL3:
    ds_read_b32 v110, v2 offset:2056
    s_waitcnt lgkmcnt(0)
    v_readfirstlane_b32 s27, v110
    s_cmp_lt_u32 s27, 1
    s_cbranch_scc1 K2_PL3
    s_mov_b32 s68, s27
    s_mov_b32 s69, s27
    s_waitcnt lgkmcnt(0)
    s_load_dwordx8 s[88:95], s[72:73], 0
    v_add_u32 v104, 155968, v8
    ds_read_b128 v[120:123], v104
    v_add_lshl_u32 v1, v0, s22, 3
    v_add_lshl_u32 v4, v0, s23, 3
    v_lshlrev_b32 v6, 3, v0
    v_add_u32 v3, 50048, v1
    v_add_u32 v5, 50048, v4
    v_lshrrev_b32 v106, 2, v1
    v_mov_b32 v8, 0
    v_mov_b32 v16, 0
    v_mov_b32 v24, 0
    v_mov_b32 v32, 0
    s_lshr_b32 s28, s24, 2
    s_add_u32 s27, s28, 0
    buffer_load_short_d16_hi v8, v106, s[60:63], s27 offen
    s_add_u32 s27, s28, 1024
    buffer_load_short_d16_hi v16, v106, s[60:63], s27 offen
    s_add_u32 s27, s28, 2048
    buffer_load_short_d16_hi v24, v106, s[60:63], s27 offen
    s_add_u32 s27, s28, 6144
    s_mov_b64 exec, s[70:71]
    buffer_load_short_d16_hi v32, v106, s[60:63], s27 offen
    s_mov_b64 exec, -1
    v_lshrrev_b32 v107, 2, v4
    v_mov_b32 v40, 0
    v_mov_b32 v48, 0
    v_mov_b32 v56, 0
    v_mov_b32 v64, 0
    s_lshr_b32 s28, s24, 2
    s_add_u32 s27, s28, 0
    buffer_load_short_d16_hi v40, v107, s[60:63], s27 offen
    s_add_u32 s27, s28, 1024
    buffer_load_short_d16_hi v48, v107, s[60:63], s27 offen
    s_add_u32 s27, s28, 2048
    buffer_load_short_d16_hi v56, v107, s[60:63], s27 offen
    s_add_u32 s27, s28, 6144
    s_mov_b64 exec, s[70:71]
    buffer_load_short_d16_hi v64, v107, s[60:63], s27 offen
    s_mov_b64 exec, -1
    s_add_u32 s27, s24, 0
    buffer_load_dwordx2 v[80:81], v4, s[64:67], s27 offen
    s_add_u32 s27, s24, 4096
    buffer_load_dwordx2 v[82:83], v4, s[64:67], s27 offen
    s_add_u32 s27, s24, 8192
    buffer_load_dwordx2 v[84:85], v4, s[64:67], s27 offen
    s_add_u32 s27, s24, 24576
    s_mov_b64 exec, s[70:71]
    buffer_load_dwordx2 v[86:87], v4, s[64:67], s27 offen
    s_mov_b64 exec, -1
    s_lshl_b32 s28, s20, 4
    s_lshl_b32 s29, s29, 7
    s_add_u32 s29, s28, s29
    s_xor_b32 s28, s29, 16384
    s_add_u32 s29, s29, 89194496
    s_add_u32 s28, s28, 89194496
    s_waitcnt vmcnt(0) lgkmcnt(0)
    s_mov_b64 exec, 1
    buffer_store_dword v88, v2, s[4:7], s28 offen sc1
    s_mov_b64 exec, -1
    s_setprio 0
    s_mov_b32 s8, 0x80000000
    s_mov_b32 s9, 0xbf0aa327
    s_mov_b32 s10, 0xbf8aa327
    s_mov_b32 s11, 0xbfcff4ba
    s_mov_b32 s12, 0xc00aa327
    s_mov_b32 s13, 0xc02dc57c
    s_mov_b32 s14, 0xc04ff4ba
    s_mov_b32 s15, 0xc0731710
    s_lshl_b32 s72, s88, 16
    s_and_b32 s73, s88, s31
    s_lshl_b32 s74, s89, 16
    s_and_b32 s75, s89, s31
    s_lshl_b32 s76, s90, 16
    s_and_b32 s77, s90, s31
    s_lshl_b32 s78, s91, 16
    s_and_b32 s79, s91, s31
    s_lshl_b32 s80, s92, 16
    s_and_b32 s81, s92, s31
    s_lshl_b32 s82, s93, 16
    s_and_b32 s83, s93, s31
    s_lshl_b32 s84, s94, 16
    s_and_b32 s85, s94, s31
    s_lshl_b32 s86, s95, 16
    s_and_b32 s87, s95, s31
    v_mul_f32 v92, 0x40731710, v8
    v_pk_add_f32 v[8:9], v[92:93], s[8:9] op_sel_hi:[0,1]
    v_pk_add_f32 v[10:11], v[92:93], s[10:11] op_sel_hi:[0,1]
    v_pk_add_f32 v[12:13], v[92:93], s[12:13] op_sel_hi:[0,1]
    v_pk_add_f32 v[14:15], v[92:93], s[14:15] op_sel_hi:[0,1]
    v_pk_mul_f32 v[8:9], v[8:9], v[8:9]
    v_pk_mul_f32 v[10:11], v[10:11], v[10:11]
    v_pk_mul_f32 v[12:13], v[12:13], v[12:13]
    v_pk_mul_f32 v[14:15], v[14:15], v[14:15]
    v_exp_f32 v8, -v8
    v_exp_f32 v9, -v9
    v_exp_f32 v10, -v10
    v_exp_f32 v11, -v11
    v_exp_f32 v12, -v12
    v_exp_f32 v13, -v13
    v_exp_f32 v14, -v14
    v_exp_f32 v15, -v15
    v_cvt_pk_bf16_f32 v124, v8, v9
    v_cvt_pk_bf16_f32 v125, v10, v11
    v_cvt_pk_bf16_f32 v126, v12, v13
    v_cvt_pk_bf16_f32 v127, v14, v15
    s_nop 1
    v_mfma_f32_32x32x16_bf16 v[104:119], v[120:123], v[124:127], 0
    v_mul_f32 v92, 0x40731710, v16
    v_pk_add_f32 v[16:17], v[92:93], s[8:9] op_sel_hi:[0,1]
    v_pk_add_f32 v[18:19], v[92:93], s[10:11] op_sel_hi:[0,1]
    v_pk_add_f32 v[20:21], v[92:93], s[12:13] op_sel_hi:[0,1]
    v_pk_add_f32 v[22:23], v[92:93], s[14:15] op_sel_hi:[0,1]
    v_pk_mul_f32 v[16:17], v[16:17], v[16:17]
    v_pk_mul_f32 v[18:19], v[18:19], v[18:19]
    v_pk_mul_f32 v[20:21], v[20:21], v[20:21]
    v_pk_mul_f32 v[22:23], v[22:23], v[22:23]
    v_exp_f32 v16, -v16
    v_exp_f32 v17, -v17
    v_exp_f32 v18, -v18
    v_exp_f32 v19, -v19
    v_exp_f32 v20, -v20
    v_exp_f32 v21, -v21
    v_exp_f32 v22, -v22
    v_exp_f32 v23, -v23
    v_pk_mul_f32 v[8:9], v[104:105], s[68:69]
    v_pk_mul_f32 v[10:11], v[106:107], s[68:69]
    v_pk_mul_f32 v[12:13], v[108:109], s[68:69]
    v_pk_mul_f32 v[14:15], v[110:111], s[68:69]
    v_cvt_pk_bf16_f32 v124, v16, v17
    v_cvt_pk_bf16_f32 v125, v18, v19
    v_cvt_pk_bf16_f32 v126, v20, v21
    v_cvt_pk_bf16_f32 v127, v22, v23
    s_nop 1
    v_mfma_f32_32x32x16_bf16 v[104:119], v[120:123], v[124:127], 0
    v_mul_f32 v92, 0x40731710, v24
    v_pk_add_f32 v[24:25], v[92:93], s[8:9] op_sel_hi:[0,1]
    v_pk_add_f32 v[26:27], v[92:93], s[10:11] op_sel_hi:[0,1]
    v_pk_add_f32 v[28:29], v[92:93], s[12:13] op_sel_hi:[0,1]
    v_pk_add_f32 v[30:31], v[92:93], s[14:15] op_sel_hi:[0,1]
    v_pk_mul_f32 v[24:25], v[24:25], v[24:25]
    v_pk_mul_f32 v[26:27], v[26:27], v[26:27]
    v_pk_mul_f32 v[28:29], v[28:29], v[28:29]
    v_pk_mul_f32 v[30:31], v[30:31], v[30:31]
    v_exp_f32 v24, -v24
    v_exp_f32 v25, -v25
    v_exp_f32 v26, -v26
    v_exp_f32 v27, -v27
    v_exp_f32 v28, -v28
    v_exp_f32 v29, -v29
    v_exp_f32 v30, -v30
    v_exp_f32 v31, -v31
    v_pk_mul_f32 v[16:17], v[104:105], s[68:69]
    v_pk_mul_f32 v[18:19], v[106:107], s[68:69]
    v_pk_mul_f32 v[20:21], v[108:109], s[68:69]
    v_pk_mul_f32 v[22:23], v[110:111], s[68:69]
    v_cvt_pk_bf16_f32 v124, v24, v25
    v_cvt_pk_bf16_f32 v125, v26, v27
    v_cvt_pk_bf16_f32 v126, v28, v29
    v_cvt_pk_bf16_f32 v127, v30, v31
    s_nop 1
    v_mfma_f32_32x32x16_bf16 v[104:119], v[120:123], v[124:127], 0
    v_mul_f32 v92, 0x40731710, v40
    v_pk_add_f32 v[40:41], v[92:93], s[8:9] op_sel_hi:[0,1]
    v_pk_add_f32 v[42:43], v[92:93], s[10:11] op_sel_hi:[0,1]
    v_pk_add_f32 v[44:45], v[92:93], s[12:13] op_sel_hi:[0,1]
    v_pk_add_f32 v[46:47], v[92:93], s[14:15] op_sel_hi:[0,1]
    v_pk_mul_f32 v[40:41], v[40:41], v[40:41]
    v_pk_mul_f32 v[42:43], v[42:43], v[42:43]
    v_pk_mul_f32 v[44:45], v[44:45], v[44:45]
    v_pk_mul_f32 v[46:47], v[46:47], v[46:47]
    v_exp_f32 v40, -v40
    v_exp_f32 v41, -v41
    v_exp_f32 v42, -v42
    v_exp_f32 v43, -v43
    v_exp_f32 v44, -v44
    v_exp_f32 v45, -v45
    v_exp_f32 v46, -v46
    v_exp_f32 v47, -v47
    v_pk_mul_f32 v[24:25], v[104:105], s[68:69]
    v_pk_mul_f32 v[26:27], v[106:107], s[68:69]
    v_pk_mul_f32 v[28:29], v[108:109], s[68:69]
    v_pk_mul_f32 v[30:31], v[110:111], s[68:69]
    v_cvt_pk_bf16_f32 v124, v40, v41
    v_cvt_pk_bf16_f32 v125, v42, v43
    v_cvt_pk_bf16_f32 v126, v44, v45
    v_cvt_pk_bf16_f32 v127, v46, v47
    s_nop 1
    v_mfma_f32_32x32x16_bf16 v[104:119], v[120:123], v[124:127], 0
    v_mul_f32 v92, 0x40731710, v48
    v_pk_add_f32 v[48:49], v[92:93], s[8:9] op_sel_hi:[0,1]
    v_pk_add_f32 v[50:51], v[92:93], s[10:11] op_sel_hi:[0,1]
    v_pk_add_f32 v[52:53], v[92:93], s[12:13] op_sel_hi:[0,1]
    v_pk_add_f32 v[54:55], v[92:93], s[14:15] op_sel_hi:[0,1]
    v_pk_mul_f32 v[48:49], v[48:49], v[48:49]
    v_pk_mul_f32 v[50:51], v[50:51], v[50:51]
    v_pk_mul_f32 v[52:53], v[52:53], v[52:53]
    v_pk_mul_f32 v[54:55], v[54:55], v[54:55]
    v_exp_f32 v48, -v48
    v_exp_f32 v49, -v49
    v_exp_f32 v50, -v50
    v_exp_f32 v51, -v51
    v_exp_f32 v52, -v52
    v_exp_f32 v53, -v53
    v_exp_f32 v54, -v54
    v_exp_f32 v55, -v55
    v_pk_mul_f32 v[40:41], v[104:105], s[68:69]
    v_pk_mul_f32 v[42:43], v[106:107], s[68:69]
    v_pk_mul_f32 v[44:45], v[108:109], s[68:69]
    v_pk_mul_f32 v[46:47], v[110:111], s[68:69]
    v_cvt_pk_bf16_f32 v72, v112, v113
    v_cvt_pk_bf16_f32 v73, v114, v115
    v_cvt_pk_bf16_f32 v124, v48, v49
    v_cvt_pk_bf16_f32 v125, v50, v51
    v_cvt_pk_bf16_f32 v126, v52, v53
    v_cvt_pk_bf16_f32 v127, v54, v55
    s_nop 1
    v_mfma_f32_32x32x16_bf16 v[104:119], v[120:123], v[124:127], 0
    v_mul_f32 v92, 0x40731710, v56
    v_pk_add_f32 v[56:57], v[92:93], s[8:9] op_sel_hi:[0,1]
    v_pk_add_f32 v[58:59], v[92:93], s[10:11] op_sel_hi:[0,1]
    v_pk_add_f32 v[60:61], v[92:93], s[12:13] op_sel_hi:[0,1]
    v_pk_add_f32 v[62:63], v[92:93], s[14:15] op_sel_hi:[0,1]
    v_pk_mul_f32 v[56:57], v[56:57], v[56:57]
    v_pk_mul_f32 v[58:59], v[58:59], v[58:59]
    v_pk_mul_f32 v[60:61], v[60:61], v[60:61]
    v_pk_mul_f32 v[62:63], v[62:63], v[62:63]
    v_exp_f32 v56, -v56
    v_exp_f32 v57, -v57
    v_exp_f32 v58, -v58
    v_exp_f32 v59, -v59
    v_exp_f32 v60, -v60
    v_exp_f32 v61, -v61
    v_exp_f32 v62, -v62
    v_exp_f32 v63, -v63
    v_pk_mul_f32 v[48:49], v[104:105], s[68:69]
    v_pk_mul_f32 v[50:51], v[106:107], s[68:69]
    v_pk_mul_f32 v[52:53], v[108:109], s[68:69]
    v_pk_mul_f32 v[54:55], v[110:111], s[68:69]
    v_cvt_pk_bf16_f32 v74, v112, v113
    v_cvt_pk_bf16_f32 v75, v114, v115
    v_cvt_pk_bf16_f32 v124, v56, v57
    v_cvt_pk_bf16_f32 v125, v58, v59
    v_cvt_pk_bf16_f32 v126, v60, v61
    v_cvt_pk_bf16_f32 v127, v62, v63
    s_nop 1
    v_mfma_f32_32x32x16_bf16 v[104:119], v[120:123], v[124:127], 0
    s_nop 11
    v_pk_mul_f32 v[56:57], v[104:105], s[68:69]
    v_pk_mul_f32 v[58:59], v[106:107], s[68:69]
    v_pk_mul_f32 v[60:61], v[108:109], s[68:69]
    v_pk_mul_f32 v[62:63], v[110:111], s[68:69]
    v_cvt_pk_bf16_f32 v76, v112, v113
    v_cvt_pk_bf16_f32 v77, v114, v115
    s_cmp_lg_u32 s20, 0
    s_cbranch_scc1 K2_NA6
    v_mul_f32 v92, 0x40731710, v32
    v_pk_add_f32 v[32:33], v[92:93], s[8:9] op_sel_hi:[0,1]
    v_pk_add_f32 v[34:35], v[92:93], s[10:11] op_sel_hi:[0,1]
    v_pk_add_f32 v[36:37], v[92:93], s[12:13] op_sel_hi:[0,1]
    v_pk_add_f32 v[38:39], v[92:93], s[14:15] op_sel_hi:[0,1]
    v_pk_mul_f32 v[32:33], v[32:33], v[32:33]
    v_pk_mul_f32 v[34:35], v[34:35], v[34:35]
    v_pk_mul_f32 v[36:37], v[36:37], v[36:37]
    v_pk_mul_f32 v[38:39], v[38:39], v[38:39]
    v_exp_f32 v32, -v32
    v_exp_f32 v33, -v33
    v_exp_f32 v34, -v34
    v_exp_f32 v35, -v35
    v_exp_f32 v36, -v36
    v_exp_f32 v37, -v37
    v_exp_f32 v38, -v38
    v_exp_f32 v39, -v39
    v_cvt_pk_bf16_f32 v124, v32, v33
    v_cvt_pk_bf16_f32 v125, v34, v35
    v_cvt_pk_bf16_f32 v126, v36, v37
    v_cvt_pk_bf16_f32 v127, v38, v39
    s_nop 1
    v_mfma_f32_32x32x16_bf16 v[104:119], v[120:123], v[124:127], 0
    v_mul_f32 v92, 0x40731710, v64
    v_pk_add_f32 v[64:65], v[92:93], s[8:9] op_sel_hi:[0,1]
    v_pk_add_f32 v[66:67], v[92:93], s[10:11] op_sel_hi:[0,1]
    v_pk_add_f32 v[68:69], v[92:93], s[12:13] op_sel_hi:[0,1]
    v_pk_add_f32 v[70:71], v[92:93], s[14:15] op_sel_hi:[0,1]
    v_pk_mul_f32 v[64:65], v[64:65], v[64:65]
    v_pk_mul_f32 v[66:67], v[66:67], v[66:67]
    v_pk_mul_f32 v[68:69], v[68:69], v[68:69]
    v_pk_mul_f32 v[70:71], v[70:71], v[70:71]
    v_exp_f32 v64, -v64
    v_exp_f32 v65, -v65
    v_exp_f32 v66, -v66
    v_exp_f32 v67, -v67
    v_exp_f32 v68, -v68
    v_exp_f32 v69, -v69
    v_exp_f32 v70, -v70
    v_exp_f32 v71, -v71
    v_pk_mul_f32 v[32:33], v[104:105], s[68:69]
    v_pk_mul_f32 v[34:35], v[106:107], s[68:69]
    v_pk_mul_f32 v[36:37], v[108:109], s[68:69]
    v_pk_mul_f32 v[38:39], v[110:111], s[68:69]
    v_cvt_pk_bf16_f32 v124, v64, v65
    v_cvt_pk_bf16_f32 v125, v66, v67
    v_cvt_pk_bf16_f32 v126, v68, v69
    v_cvt_pk_bf16_f32 v127, v70, v71
    s_nop 1
    v_mfma_f32_32x32x16_bf16 v[104:119], v[120:123], v[124:127], 0
    s_nop 11
    v_pk_mul_f32 v[64:65], v[104:105], s[68:69]
    v_pk_mul_f32 v[66:67], v[106:107], s[68:69]
    v_pk_mul_f32 v[68:69], v[108:109], s[68:69]
    v_pk_mul_f32 v[70:71], v[110:111], s[68:69]
    v_cvt_pk_bf16_f32 v78, v112, v113
    v_cvt_pk_bf16_f32 v79, v114, v115
K2_NA6:
    v_mov_b32 v116, 0
    v_mov_b32 v100, 0
    v_mov_b32 v117, 0
    v_mov_b32 v101, 0
    v_mov_b32 v118, 0
    v_mov_b32 v102, 0
    v_mov_b32 v119, 0
    v_mov_b32 v103, 0
    s_mov_b32 s27, 16384
    s_branch K2_FL1
K2_FL0:
    s_sleep 4
    s_sub_u32 s27, s27, 1
    s_cbranch_scc0 K2_FL1
    v_mov_b32 v7, 0x8000
    ds_or_b32 v2, v7 offset:2060
    s_branch K2_FL2
K2_FL1:
    buffer_load_dword v7, v2, s[4:7], s29 offen sc1
    s_waitcnt vmcnt(0)
    v_cmp_eq_u32 vcc, 0, v7
    s_cbranch_vccnz K2_FL0
K2_FL2:
    s_mov_b32 s25, 0x40004000
    s_setprio 3
    s_waitcnt lgkmcnt(0)
    s_barrier
    ds_read_b32 v7, v2 offset:2060
    ds_read_b64 v[88:89], v1 offset:2176
    ds_read_b64 v[90:91], v3 offset:2176
    ds_read_b64 v[92:93], v1 offset:6272
    ds_read_b64 v[94:95], v3 offset:6272
    ds_read_b64 v[96:97], v1 offset:10368
    ds_read_b64 v[98:99], v3 offset:10368
    s_mov_b64 exec, s[70:71]
    ds_read_b64 v[100:101], v1 offset:26752
    ds_read_b64 v[102:103], v3 offset:26752
    s_mov_b64 exec, -1
    ds_read_b64 v[104:105], v4 offset:2176
    ds_read_b64 v[106:107], v5 offset:2176
    ds_read_b64 v[108:109], v4 offset:6272
    ds_read_b64 v[110:111], v5 offset:6272
    ds_read_b64 v[112:113], v4 offset:10368
    ds_read_b64 v[114:115], v5 offset:10368
    s_mov_b64 exec, s[70:71]
    ds_read_b64 v[116:117], v4 offset:26752
    ds_read_b64 v[118:119], v5 offset:26752
    s_mov_b64 exec, -1
    s_waitcnt lgkmcnt(8)
    v_or3_b32 v7, v7, v88, v89
    v_or3_b32 v7, v7, v90, v91
    v_or3_b32 v7, v7, v92, v93
    v_or3_b32 v7, v7, v94, v95
    v_or3_b32 v7, v7, v96, v97
    v_or3_b32 v7, v7, v98, v99
    v_or3_b32 v7, v7, v100, v101
    v_or3_b32 v7, v7, v102, v103
    v_and_b32 v7, s33, v7
    v_cmp_eq_u32 vcc, 0, v7
    v_pk_sub_i16 v88, v88, s25
    v_pk_sub_i16 v89, v89, s25
    v_pk_sub_i16 v90, v90, s25
    v_pk_sub_i16 v91, v91, s25
    v_cvt_f32_i32_sdwa v124, sext(v88) dst_sel:DWORD dst_unused:UNUSED_PAD src0_sel:WORD_0
    v_cvt_f32_i32_sdwa v125, sext(v88) dst_sel:DWORD dst_unused:UNUSED_PAD src0_sel:WORD_1
    v_cvt_f32_i32_sdwa v126, sext(v89) dst_sel:DWORD dst_unused:UNUSED_PAD src0_sel:WORD_0
    v_cvt_f32_i32_sdwa v127, sext(v89) dst_sel:DWORD dst_unused:UNUSED_PAD src0_sel:WORD_1
    v_pk_mul_f32 v[124:125], v[8:9], v[124:125]
    v_pk_mul_f32 v[126:127], v[10:11], v[126:127]
    v_cvt_f32_i32_sdwa v8, sext(v90) dst_sel:DWORD dst_unused:UNUSED_PAD src0_sel:WORD_0
    v_cvt_f32_i32_sdwa v9, sext(v90) dst_sel:DWORD dst_unused:UNUSED_PAD src0_sel:WORD_1
    v_cvt_f32_i32_sdwa v10, sext(v91) dst_sel:DWORD dst_unused:UNUSED_PAD src0_sel:WORD_0
    v_cvt_f32_i32_sdwa v11, sext(v91) dst_sel:DWORD dst_unused:UNUSED_PAD src0_sel:WORD_1
    v_pk_fma_f32 v[124:125], v[12:13], v[8:9], v[124:125]
    v_pk_fma_f32 v[126:127], v[14:15], v[10:11], v[126:127]
    s_add_u32 s27, s36, 0
    v_cvt_pk_bf16_f32 v88, v124, v125
    v_cvt_pk_bf16_f32 v89, v126, v127
    v_cndmask_b32 v88, -2, v88, vcc
    buffer_store_dwordx2 v[88:89], v6, s[4:7], s27 offen sc1
    v_pk_sub_i16 v92, v92, s25
    v_pk_sub_i16 v93, v93, s25
    v_pk_sub_i16 v94, v94, s25
    v_pk_sub_i16 v95, v95, s25
    v_cvt_f32_i32_sdwa v124, sext(v92) dst_sel:DWORD dst_unused:UNUSED_PAD src0_sel:WORD_0
    v_cvt_f32_i32_sdwa v125, sext(v92) dst_sel:DWORD dst_unused:UNUSED_PAD src0_sel:WORD_1
    v_cvt_f32_i32_sdwa v126, sext(v93) dst_sel:DWORD dst_unused:UNUSED_PAD src0_sel:WORD_0
    v_cvt_f32_i32_sdwa v127, sext(v93) dst_sel:DWORD dst_unused:UNUSED_PAD src0_sel:WORD_1
    v_pk_mul_f32 v[124:125], v[16:17], v[124:125]
    v_pk_mul_f32 v[126:127], v[18:19], v[126:127]
    v_cvt_f32_i32_sdwa v16, sext(v94) dst_sel:DWORD dst_unused:UNUSED_PAD src0_sel:WORD_0
    v_cvt_f32_i32_sdwa v17, sext(v94) dst_sel:DWORD dst_unused:UNUSED_PAD src0_sel:WORD_1
    v_cvt_f32_i32_sdwa v18, sext(v95) dst_sel:DWORD dst_unused:UNUSED_PAD src0_sel:WORD_0
    v_cvt_f32_i32_sdwa v19, sext(v95) dst_sel:DWORD dst_unused:UNUSED_PAD src0_sel:WORD_1
    v_pk_fma_f32 v[124:125], v[20:21], v[16:17], v[124:125]
    v_pk_fma_f32 v[126:127], v[22:23], v[18:19], v[126:127]
    s_add_u32 s27, s36, 4096
    v_cvt_pk_bf16_f32 v92, v124, v125
    v_cvt_pk_bf16_f32 v93, v126, v127
    buffer_store_dwordx2 v[92:93], v6, s[4:7], s27 offen sc1
    v_pk_sub_i16 v96, v96, s25
    v_pk_sub_i16 v97, v97, s25
    v_pk_sub_i16 v98, v98, s25
    v_pk_sub_i16 v99, v99, s25
    v_cvt_f32_i32_sdwa v124, sext(v96) dst_sel:DWORD dst_unused:UNUSED_PAD src0_sel:WORD_0
    v_cvt_f32_i32_sdwa v125, sext(v96) dst_sel:DWORD dst_unused:UNUSED_PAD src0_sel:WORD_1
    v_cvt_f32_i32_sdwa v126, sext(v97) dst_sel:DWORD dst_unused:UNUSED_PAD src0_sel:WORD_0
    v_cvt_f32_i32_sdwa v127, sext(v97) dst_sel:DWORD dst_unused:UNUSED_PAD src0_sel:WORD_1
    v_pk_mul_f32 v[124:125], v[24:25], v[124:125]
    v_pk_mul_f32 v[126:127], v[26:27], v[126:127]
    v_cvt_f32_i32_sdwa v24, sext(v98) dst_sel:DWORD dst_unused:UNUSED_PAD src0_sel:WORD_0
    v_cvt_f32_i32_sdwa v25, sext(v98) dst_sel:DWORD dst_unused:UNUSED_PAD src0_sel:WORD_1
    v_cvt_f32_i32_sdwa v26, sext(v99) dst_sel:DWORD dst_unused:UNUSED_PAD src0_sel:WORD_0
    v_cvt_f32_i32_sdwa v27, sext(v99) dst_sel:DWORD dst_unused:UNUSED_PAD src0_sel:WORD_1
    v_pk_fma_f32 v[124:125], v[28:29], v[24:25], v[124:125]
    v_pk_fma_f32 v[126:127], v[30:31], v[26:27], v[126:127]
    s_add_u32 s27, s36, 8192
    v_cvt_pk_bf16_f32 v96, v124, v125
    v_cvt_pk_bf16_f32 v97, v126, v127
    buffer_store_dwordx2 v[96:97], v6, s[4:7], s27 offen sc1
    s_cmp_lg_u32 s20, 0
    s_cbranch_scc1 K2_NSP
    s_mov_b64 exec, s[70:71]
    v_pk_sub_i16 v100, v100, s25
    v_pk_sub_i16 v101, v101, s25
    v_pk_sub_i16 v102, v102, s25
    v_pk_sub_i16 v103, v103, s25
    v_cvt_f32_i32_sdwa v124, sext(v100) dst_sel:DWORD dst_unused:UNUSED_PAD src0_sel:WORD_0
    v_cvt_f32_i32_sdwa v125, sext(v100) dst_sel:DWORD dst_unused:UNUSED_PAD src0_sel:WORD_1
    v_cvt_f32_i32_sdwa v126, sext(v101) dst_sel:DWORD dst_unused:UNUSED_PAD src0_sel:WORD_0
    v_cvt_f32_i32_sdwa v127, sext(v101) dst_sel:DWORD dst_unused:UNUSED_PAD src0_sel:WORD_1
    v_pk_mul_f32 v[124:125], v[32:33], v[124:125]
    v_pk_mul_f32 v[126:127], v[34:35], v[126:127]
    v_cvt_f32_i32_sdwa v32, sext(v102) dst_sel:DWORD dst_unused:UNUSED_PAD src0_sel:WORD_0
    v_cvt_f32_i32_sdwa v33, sext(v102) dst_sel:DWORD dst_unused:UNUSED_PAD src0_sel:WORD_1
    v_cvt_f32_i32_sdwa v34, sext(v103) dst_sel:DWORD dst_unused:UNUSED_PAD src0_sel:WORD_0
    v_cvt_f32_i32_sdwa v35, sext(v103) dst_sel:DWORD dst_unused:UNUSED_PAD src0_sel:WORD_1
    v_pk_fma_f32 v[124:125], v[36:37], v[32:33], v[124:125]
    v_pk_fma_f32 v[126:127], v[38:39], v[34:35], v[126:127]
    s_add_u32 s27, s36, 24576
    v_cvt_pk_bf16_f32 v100, v124, v125
    v_cvt_pk_bf16_f32 v101, v126, v127
    buffer_store_dwordx2 v[100:101], v6, s[4:7], s27 offen sc1
    s_mov_b64 exec, -1
K2_NSP:
    s_setprio 1
    s_waitcnt lgkmcnt(0)
    v_or3_b32 v7, v7, v104, v105
    v_or3_b32 v7, v7, v106, v107
    v_or3_b32 v7, v7, v108, v109
    v_or3_b32 v7, v7, v110, v111
    v_or3_b32 v7, v7, v112, v113
    v_or3_b32 v7, v7, v114, v115
    v_or3_b32 v7, v7, v116, v117
    v_or3_b32 v7, v7, v118, v119
    v_and_b32 v7, s33, v7
    v_cmp_ne_u32 vcc, 0, v7
    s_cbranch_vccnz K2_TEP
    s_add_u32 s27, s38, 0
    buffer_load_dwordx2 v[88:89], v6, s[4:7], s27 offen sc1
    s_add_u32 s27, s38, 4096
    buffer_load_dwordx2 v[92:93], v6, s[4:7], s27 offen sc1
    s_add_u32 s27, s38, 8192
    buffer_load_dwordx2 v[96:97], v6, s[4:7], s27 offen sc1
    s_add_u32 s27, s38, 24576
    s_mov_b64 exec, s[70:71]
    buffer_load_dwordx2 v[100:101], v6, s[4:7], s27 offen sc1
    s_mov_b64 exec, -1
    s_mov_b32 exec_lo, 0x11111111
    s_mov_b32 exec_hi, 0x11111111
    s_pack_ll_b32_b16 s27, s88, s90
    v_mov_b32 v90, s27
    s_pack_ll_b32_b16 s27, s92, s94
    v_mov_b32 v91, s27
    s_mov_b32 exec_lo, 0x22222222
    s_mov_b32 exec_hi, 0x22222222
    s_pack_hh_b32_b16 s27, s88, s90
    v_mov_b32 v90, s27
    s_pack_hh_b32_b16 s27, s92, s94
    v_mov_b32 v91, s27
    s_mov_b32 exec_lo, 0x44444444
    s_mov_b32 exec_hi, 0x44444444
    s_pack_ll_b32_b16 s27, s89, s91
    v_mov_b32 v90, s27
    s_pack_ll_b32_b16 s27, s93, s95
    v_mov_b32 v91, s27
    s_mov_b32 exec_lo, 0x88888888
    s_mov_b32 exec_hi, 0x88888888
    s_pack_hh_b32_b16 s27, s89, s91
    v_mov_b32 v90, s27
    s_pack_hh_b32_b16 s27, s93, s95
    v_mov_b32 v91, s27
    s_mov_b64 exec, -1
    v_pk_sub_i16 v104, v104, s25
    v_pk_sub_i16 v105, v105, s25
    v_pk_sub_i16 v106, v106, s25
    v_pk_sub_i16 v107, v107, s25
    v_cvt_f32_i32_sdwa v124, sext(v104) dst_sel:DWORD dst_unused:UNUSED_PAD src0_sel:WORD_0
    v_cvt_f32_i32_sdwa v125, sext(v104) dst_sel:DWORD dst_unused:UNUSED_PAD src0_sel:WORD_1
    v_cvt_f32_i32_sdwa v126, sext(v105) dst_sel:DWORD dst_unused:UNUSED_PAD src0_sel:WORD_0
    v_cvt_f32_i32_sdwa v127, sext(v105) dst_sel:DWORD dst_unused:UNUSED_PAD src0_sel:WORD_1
    v_pk_mul_f32 v[124:125], v[40:41], v[124:125]
    v_pk_mul_f32 v[126:127], v[42:43], v[126:127]
    v_cvt_f32_i32_sdwa v40, sext(v106) dst_sel:DWORD dst_unused:UNUSED_PAD src0_sel:WORD_0
    v_cvt_f32_i32_sdwa v41, sext(v106) dst_sel:DWORD dst_unused:UNUSED_PAD src0_sel:WORD_1
    v_cvt_f32_i32_sdwa v42, sext(v107) dst_sel:DWORD dst_unused:UNUSED_PAD src0_sel:WORD_0
    v_cvt_f32_i32_sdwa v43, sext(v107) dst_sel:DWORD dst_unused:UNUSED_PAD src0_sel:WORD_1
    v_pk_fma_f32 v[124:125], v[44:45], v[40:41], v[124:125]
    v_pk_fma_f32 v[126:127], v[46:47], v[42:43], v[126:127]
    v_cvt_pk_bf16_f32 v40, v124, v125
    v_cvt_pk_bf16_f32 v41, v126, v127
    v_lshlrev_b32 v8, 16, v72
    v_and_b32 v9, s31, v72
    v_lshlrev_b32 v10, 16, v73
    v_and_b32 v11, s31, v73
    v_mfma_f32_4x4x4_16b_bf16 v[104:107], v[90:91], v[40:41], 0
    v_lshlrev_b32 v12, 16, v80
    v_and_b32 v13, s31, v80
    v_lshlrev_b32 v14, 16, v81
    v_and_b32 v15, s31, v81
    v_pk_sub_i16 v108, v108, s25
    v_pk_sub_i16 v109, v109, s25
    v_pk_sub_i16 v110, v110, s25
    v_pk_sub_i16 v111, v111, s25
    v_cvt_f32_i32_sdwa v124, sext(v108) dst_sel:DWORD dst_unused:UNUSED_PAD src0_sel:WORD_0
    v_cvt_f32_i32_sdwa v125, sext(v108) dst_sel:DWORD dst_unused:UNUSED_PAD src0_sel:WORD_1
    v_cvt_f32_i32_sdwa v126, sext(v109) dst_sel:DWORD dst_unused:UNUSED_PAD src0_sel:WORD_0
    v_cvt_f32_i32_sdwa v127, sext(v109) dst_sel:DWORD dst_unused:UNUSED_PAD src0_sel:WORD_1
    v_pk_mul_f32 v[124:125], v[48:49], v[124:125]
    v_pk_mul_f32 v[126:127], v[50:51], v[126:127]
    v_cvt_f32_i32_sdwa v48, sext(v110) dst_sel:DWORD dst_unused:UNUSED_PAD src0_sel:WORD_0
    v_cvt_f32_i32_sdwa v49, sext(v110) dst_sel:DWORD dst_unused:UNUSED_PAD src0_sel:WORD_1
    v_cvt_f32_i32_sdwa v50, sext(v111) dst_sel:DWORD dst_unused:UNUSED_PAD src0_sel:WORD_0
    v_cvt_f32_i32_sdwa v51, sext(v111) dst_sel:DWORD dst_unused:UNUSED_PAD src0_sel:WORD_1
    v_pk_fma_f32 v[124:125], v[52:53], v[48:49], v[124:125]
    v_pk_fma_f32 v[126:127], v[54:55], v[50:51], v[126:127]
    v_cvt_pk_bf16_f32 v48, v124, v125
    v_cvt_pk_bf16_f32 v49, v126, v127
    v_lshlrev_b32 v16, 16, v74
    v_and_b32 v17, s31, v74
    v_lshlrev_b32 v18, 16, v75
    v_and_b32 v19, s31, v75
    v_mfma_f32_4x4x4_16b_bf16 v[108:111], v[90:91], v[48:49], 0
    v_lshlrev_b32 v20, 16, v82
    v_and_b32 v21, s31, v82
    v_lshlrev_b32 v22, 16, v83
    v_and_b32 v23, s31, v83
    v_pk_sub_i16 v112, v112, s25
    v_pk_sub_i16 v113, v113, s25
    v_pk_sub_i16 v114, v114, s25
    v_pk_sub_i16 v115, v115, s25
    v_cvt_f32_i32_sdwa v124, sext(v112) dst_sel:DWORD dst_unused:UNUSED_PAD src0_sel:WORD_0
    v_cvt_f32_i32_sdwa v125, sext(v112) dst_sel:DWORD dst_unused:UNUSED_PAD src0_sel:WORD_1
    v_cvt_f32_i32_sdwa v126, sext(v113) dst_sel:DWORD dst_unused:UNUSED_PAD src0_sel:WORD_0
    v_cvt_f32_i32_sdwa v127, sext(v113) dst_sel:DWORD dst_unused:UNUSED_PAD src0_sel:WORD_1
    v_pk_mul_f32 v[124:125], v[56:57], v[124:125]
    v_pk_mul_f32 v[126:127], v[58:59], v[126:127]
    v_cvt_f32_i32_sdwa v56, sext(v114) dst_sel:DWORD dst_unused:UNUSED_PAD src0_sel:WORD_0
    v_cvt_f32_i32_sdwa v57, sext(v114) dst_sel:DWORD dst_unused:UNUSED_PAD src0_sel:WORD_1
    v_cvt_f32_i32_sdwa v58, sext(v115) dst_sel:DWORD dst_unused:UNUSED_PAD src0_sel:WORD_0
    v_cvt_f32_i32_sdwa v59, sext(v115) dst_sel:DWORD dst_unused:UNUSED_PAD src0_sel:WORD_1
    v_pk_fma_f32 v[124:125], v[60:61], v[56:57], v[124:125]
    v_pk_fma_f32 v[126:127], v[62:63], v[58:59], v[126:127]
    v_cvt_pk_bf16_f32 v56, v124, v125
    v_cvt_pk_bf16_f32 v57, v126, v127
    v_lshlrev_b32 v24, 16, v76
    v_and_b32 v25, s31, v76
    v_lshlrev_b32 v26, 16, v77
    v_and_b32 v27, s31, v77
    v_mfma_f32_4x4x4_16b_bf16 v[112:115], v[90:91], v[56:57], 0
    v_lshlrev_b32 v28, 16, v84
    v_and_b32 v29, s31, v84
    v_lshlrev_b32 v30, 16, v85
    v_and_b32 v31, s31, v85
    s_cmp_lg_u32 s20, 0
    s_cbranch_scc1 K2_NOP
    v_pk_sub_i16 v116, v116, s25
    v_pk_sub_i16 v117, v117, s25
    v_pk_sub_i16 v118, v118, s25
    v_pk_sub_i16 v119, v119, s25
    v_cvt_f32_i32_sdwa v124, sext(v116) dst_sel:DWORD dst_unused:UNUSED_PAD src0_sel:WORD_0
    v_cvt_f32_i32_sdwa v125, sext(v116) dst_sel:DWORD dst_unused:UNUSED_PAD src0_sel:WORD_1
    v_cvt_f32_i32_sdwa v126, sext(v117) dst_sel:DWORD dst_unused:UNUSED_PAD src0_sel:WORD_0
    v_cvt_f32_i32_sdwa v127, sext(v117) dst_sel:DWORD dst_unused:UNUSED_PAD src0_sel:WORD_1
    v_pk_mul_f32 v[124:125], v[64:65], v[124:125]
    v_pk_mul_f32 v[126:127], v[66:67], v[126:127]
    v_cvt_f32_i32_sdwa v64, sext(v118) dst_sel:DWORD dst_unused:UNUSED_PAD src0_sel:WORD_0
    v_cvt_f32_i32_sdwa v65, sext(v118) dst_sel:DWORD dst_unused:UNUSED_PAD src0_sel:WORD_1
    v_cvt_f32_i32_sdwa v66, sext(v119) dst_sel:DWORD dst_unused:UNUSED_PAD src0_sel:WORD_0
    v_cvt_f32_i32_sdwa v67, sext(v119) dst_sel:DWORD dst_unused:UNUSED_PAD src0_sel:WORD_1
    v_pk_fma_f32 v[124:125], v[68:69], v[64:65], v[124:125]
    v_pk_fma_f32 v[126:127], v[70:71], v[66:67], v[126:127]
    v_cvt_pk_bf16_f32 v64, v124, v125
    v_cvt_pk_bf16_f32 v65, v126, v127
    v_lshlrev_b32 v32, 16, v78
    v_and_b32 v33, s31, v78
    v_lshlrev_b32 v34, 16, v79
    v_and_b32 v35, s31, v79
    v_mfma_f32_4x4x4_16b_bf16 v[116:119], v[90:91], v[64:65], 0
    v_lshlrev_b32 v36, 16, v86
    v_and_b32 v37, s31, v86
    v_lshlrev_b32 v38, 16, v87
    v_and_b32 v39, s31, v87
K2_NOP:
    s_mov_b32 s28, 16384
    s_mov_b32 s29, 0xff800000
    s_branch K2_PXP
K2_PWP:
    s_add_u32 s27, s38, 0
    buffer_load_dwordx2 v[88:89], v6, s[4:7], s27 offen sc1
    s_add_u32 s27, s38, 4096
    buffer_load_dwordx2 v[92:93], v6, s[4:7], s27 offen sc1
    s_add_u32 s27, s38, 8192
    buffer_load_dwordx2 v[96:97], v6, s[4:7], s27 offen sc1
    s_add_u32 s27, s38, 24576
    s_mov_b64 exec, s[70:71]
    buffer_load_dwordx2 v[100:101], v6, s[4:7], s27 offen sc1
    s_mov_b64 exec, -1
K2_PXP:
    s_waitcnt vmcnt(0)
    v_max3_u32 v124, v88, v89, 0
    v_max3_u32 v124, v92, v93, v124
    v_max3_u32 v124, v96, v97, v124
    v_max3_u32 v124, v100, v101, v124
    v_cmp_le_u32 vcc, s29, v124
    s_cbranch_vccnz K2_PRP
    v_mfma_f32_4x4x4_16b_bf16 v[104:107], v[90:91], v[88:89], v[104:107]
    v_mfma_f32_4x4x4_16b_bf16 v[108:111], v[90:91], v[92:93], v[108:111]
    v_mfma_f32_4x4x4_16b_bf16 v[112:115], v[90:91], v[96:97], v[112:115]
    s_add_u32 s27, s24, 0
    s_nop 2
    v_pk_fma_f32 v[104:105], v[104:105], v[8:9], v[12:13]
    v_pk_fma_f32 v[106:107], v[106:107], v[10:11], v[14:15]
    v_cvt_pk_bf16_f32 v40, v104, v105
    v_cvt_pk_bf16_f32 v41, v106, v107
    buffer_store_dwordx2 v[40:41], v4, s[16:19], s27 offen
    s_add_u32 s27, s24, 4096
    v_pk_fma_f32 v[108:109], v[108:109], v[16:17], v[20:21]
    v_pk_fma_f32 v[110:111], v[110:111], v[18:19], v[22:23]
    v_cvt_pk_bf16_f32 v48, v108, v109
    v_cvt_pk_bf16_f32 v49, v110, v111
    buffer_store_dwordx2 v[48:49], v4, s[16:19], s27 offen
    s_add_u32 s27, s24, 8192
    v_pk_fma_f32 v[112:113], v[112:113], v[24:25], v[28:29]
    v_pk_fma_f32 v[114:115], v[114:115], v[26:27], v[30:31]
    v_cvt_pk_bf16_f32 v56, v112, v113
    v_cvt_pk_bf16_f32 v57, v114, v115
    buffer_store_dwordx2 v[56:57], v4, s[16:19], s27 offen
    s_cmp_lg_u32 s20, 0
    s_cbranch_scc1 K2_TEP
    v_mfma_f32_4x4x4_16b_bf16 v[116:119], v[90:91], v[100:101], v[116:119]
    s_add_u32 s27, s24, 24576
    s_nop 4
    v_pk_fma_f32 v[116:117], v[116:117], v[32:33], v[36:37]
    v_pk_fma_f32 v[118:119], v[118:119], v[34:35], v[38:39]
    v_cvt_pk_bf16_f32 v64, v116, v117
    v_cvt_pk_bf16_f32 v65, v118, v119
    s_mov_b64 exec, s[70:71]
    buffer_store_dwordx2 v[64:65], v4, s[16:19], s27 offen
    s_mov_b64 exec, -1
K2_TEP:
    v_cmp_ne_u32 vcc, 0, v7
    s_and_b64 exec, exec, vcc
    ds_or_b32 v2, v7 offset:2060
    s_mov_b64 exec, -1
    s_waitcnt lgkmcnt(0)
    s_barrier
    ds_read_b32 v7, v2 offset:2060
    s_waitcnt lgkmcnt(0)
    v_cmp_ne_u32 vcc, 0, v7
    s_cbranch_vccz K2_FIN
    s_barrier
    s_waitcnt vmcnt(0)
    s_barrier
K2_SFIN:
    ds_read_b32 v7, v2 offset:2056
    v_mov_b32 v1, v0
    s_lshr_b32 s29, s24, 2
    s_mov_b32 s28, 0
    s_waitcnt lgkmcnt(0)
    v_readfirstlane_b32 s68, v7
    v_readfirstlane_b32 s69, v7
K2_SFL:
    v_min_u32 v32, 3124, v1
    v_add_lshl_u32 v4, v32, s23, 3
    v_lshlrev_b32 v32, 2, v32
    v_add_u32 v33, 50048, v32
    v_lshrrev_b32 v34, 2, v4
    buffer_load_ushort v8, v34, s[60:63], s29 offen
    buffer_load_dwordx2 v[28:29], v4, s[64:67], s24 offen
    s_waitcnt vmcnt(0)
    v_lshlrev_b32 v8, 16, v8
    v_mul_f32 v98, 0x40731710, v8
    v_pk_add_f32 v[8:9], v[98:99], s[8:9] op_sel_hi:[0,1]
    v_pk_add_f32 v[10:11], v[98:99], s[10:11] op_sel_hi:[0,1]
    v_pk_add_f32 v[12:13], v[98:99], s[12:13] op_sel_hi:[0,1]
    v_pk_add_f32 v[14:15], v[98:99], s[14:15] op_sel_hi:[0,1]
    v_pk_mul_f32 v[8:9], v[8:9], v[8:9]
    v_pk_mul_f32 v[10:11], v[10:11], v[10:11]
    v_pk_mul_f32 v[12:13], v[12:13], v[12:13]
    v_pk_mul_f32 v[14:15], v[14:15], v[14:15]
    v_exp_f32 v8, -v8
    v_exp_f32 v9, -v9
    v_exp_f32 v10, -v10
    v_exp_f32 v11, -v11
    v_exp_f32 v12, -v12
    v_exp_f32 v13, -v13
    v_exp_f32 v14, -v14
    v_exp_f32 v15, -v15
    v_cvt_pk_bf16_f32 v124, v8, v9
    v_cvt_pk_bf16_f32 v125, v10, v11
    v_cvt_pk_bf16_f32 v126, v12, v13
    v_cvt_pk_bf16_f32 v127, v14, v15
    s_nop 1
    v_mfma_f32_32x32x16_bf16 v[104:119], v[120:123], v[124:127], 0
    s_nop 11
    v_pk_mul_f32 v[8:9], v[104:105], s[68:69]
    v_pk_mul_f32 v[10:11], v[106:107], s[68:69]
    v_pk_mul_f32 v[12:13], v[108:109], s[68:69]
    v_pk_mul_f32 v[14:15], v[110:111], s[68:69]
    v_cvt_pk_bf16_f32 v24, v112, v113
    v_cvt_pk_bf16_f32 v25, v114, v115
    v_lshlrev_b32 v16, 16, v24
    v_and_b32 v17, s31, v24
    v_lshlrev_b32 v18, 16, v25
    v_and_b32 v19, s31, v25
    v_lshlrev_b32 v20, 16, v28
    v_and_b32 v21, s31, v28
    v_lshlrev_b32 v22, 16, v29
    v_and_b32 v23, s31, v29
    ds_read_b32 v104, v32 offset:2176
    ds_read_b32 v105, v32 offset:14688
    ds_read_b32 v106, v32 offset:27200
    ds_read_b32 v107, v32 offset:39712
    ds_read_b32 v108, v33 offset:2176
    ds_read_b32 v109, v33 offset:14688
    ds_read_b32 v110, v33 offset:27200
    ds_read_b32 v111, v33 offset:39712
    s_waitcnt lgkmcnt(0)
    v_cvt_f32_i32 v104, v104
    v_cvt_f32_i32 v105, v105
    v_cvt_f32_i32 v106, v106
    v_cvt_f32_i32 v107, v107
    v_cvt_f32_i32 v108, v108
    v_cvt_f32_i32 v109, v109
    v_cvt_f32_i32 v110, v110
    v_cvt_f32_i32 v111, v111
    v_pk_mul_f32 v[124:125], v[8:9], v[104:105]
    v_pk_mul_f32 v[126:127], v[10:11], v[106:107]
    v_pk_fma_f32 v[124:125], v[12:13], v[108:109], v[124:125]
    v_pk_fma_f32 v[126:127], v[14:15], v[110:111], v[126:127]
    v_mov_b32 v112, v125
    v_mov_b32 v114, v127
    v_pk_mul_f32 v[8:9], v[124:125], s[72:73] op_sel_hi:[0,1]
    v_pk_mul_f32 v[10:11], v[124:125], s[74:75] op_sel_hi:[0,1]
    v_pk_fma_f32 v[8:9], v[126:127], s[80:81], v[8:9] op_sel_hi:[0,1,1]
    v_pk_fma_f32 v[10:11], v[126:127], s[82:83], v[10:11] op_sel_hi:[0,1,1]
    v_pk_fma_f32 v[8:9], v[112:113], s[76:77], v[8:9] op_sel_hi:[0,1,1]
    v_pk_fma_f32 v[10:11], v[112:113], s[78:79], v[10:11] op_sel_hi:[0,1,1]
    v_pk_fma_f32 v[8:9], v[114:115], s[84:85], v[8:9] op_sel_hi:[0,1,1]
    v_pk_fma_f32 v[10:11], v[114:115], s[86:87], v[10:11] op_sel_hi:[0,1,1]
    v_pk_fma_f32 v[8:9], v[8:9], v[16:17], v[20:21]
    v_pk_fma_f32 v[10:11], v[10:11], v[18:19], v[22:23]
    v_cvt_pk_bf16_f32 v20, v8, v9
    v_cvt_pk_bf16_f32 v21, v10, v11
    buffer_store_dwordx2 v[20:21], v4, s[16:19], s24 offen
    v_add_u32 v1, 512, v1
    s_add_u32 s28, s28, 1
    s_cmp_lt_u32 s28, 7
    s_cbranch_scc1 K2_SFL
    s_branch K2_FIN
K2_PRP:
    v_cmp_eq_u32 vcc, -1, v124
    s_cbranch_vccz K2_PVP
    s_sub_u32 s28, s28, 1
    s_cbranch_scc0 K2_PWP
K2_PVP:
    v_mov_b32 v7, 0x8000
    s_branch K2_TEP
K2_CONS:
    s_sub_u32 s20, s20, 8
    v_add_u32 v126, -512, v0
    v_mov_b32 v113, 0x40004000
    v_cmp_le_u32 vcc, 136, v126
    v_lshlrev_b32 v112, 4, v126
    s_nop 0
    v_cndmask_b32 v108, 0, v113, vcc
    v_cndmask_b32 v109, 0, v113, vcc
    v_cndmask_b32 v110, 0, v113, vcc
    v_cndmask_b32 v111, 0, v113, vcc
    ds_write_b128 v112, v[108:111]
    v_mov_b32 v108, v113
    v_mov_b32 v109, v113
    v_mov_b32 v110, v113
    v_mov_b32 v111, v113
    v_lshlrev_b32 v113, 5, v1
    s_mov_b32 s28, 89128960
    s_waitcnt lgkmcnt(0)
    s_barrier
    buffer_load_dwordx4 v[32:35], v113, s[4:7], s28 offen
    buffer_load_dwordx4 v[36:39], v113, s[4:7], s28 offen offset:16
    s_load_dwordx2 s[60:61], s[0:1], 24
    s_load_dwordx2 s[56:57], s[0:1], 56
    s_load_dwordx2 s[52:53], s[0:1], 64
    s_load_dwordx2 s[64:65], s[0:1], 0
    s_load_dwordx2 s[72:73], s[0:1], 80
    s_load_dwordx2 s[16:17], s[0:1], 88
    s_mov_b32 s62, 1600000
    s_mov_b32 s63, 0x00020000
    s_mov_b32 s54, 128
    s_mov_b32 s55, 0x00020000
    s_mov_b32 s58, 64
    s_mov_b32 s59, 0x00020000
    s_mov_b32 s66, 6400000
    s_mov_b32 s67, 0x00020000
    s_mov_b32 s18, 6400000
    s_mov_b32 s19, 0x00020000
    s_lshr_b32 s27, s21, 7
    s_and_b32 s28, s21, 127
    s_mul_i32 s22, s27, 3125
    s_sub_u32 s23, 3125, s22
    s_mul_i32 s28, s28, 6250
    s_lshl_b32 s24, s28, 3
    s_add_u32 s28, s28, s23
    s_mul_i32 s36, s21, 32768
    s_add_u32 s36, s36, 90177536
    s_xor_b32 s29, s21, 128
    s_mul_i32 s38, s29, 32768
    s_add_u32 s38, s38, 90177536
    s_mov_b32 s33, 0x80008000
    v_mov_b32 v56, 0
    v_mov_b32 v57, 0
    v_mov_b32 v58, 0
    v_mov_b32 v59, 0
    v_mov_b32 v60, 0
    v_mov_b32 v61, 0
    v_mov_b32 v62, 0
    v_mov_b32 v63, 0
    v_and_b32 v65, 3, v126
    v_lshlrev_b32 v65, 1, v65
    v_and_or_b32 v64, v126, 8, v65
    v_cmp_gt_u32 s[70:71], 53, v126
    s_waitcnt lgkmcnt(0)
    s_load_dwordx8 s[88:95], s[72:73], 0
    s_mov_b32 exec_lo, 0x00000f0f
    s_mov_b32 exec_hi, 0x0000f0f0
    buffer_load_short_d16 v56, v64, s[52:55], 0 offen offset:0
    buffer_load_short_d16_hi v60, v64, s[52:55], 0 offen offset:16
    buffer_load_short_d16 v57, v64, s[52:55], 0 offen offset:32
    buffer_load_short_d16_hi v61, v64, s[52:55], 0 offen offset:48
    buffer_load_short_d16 v58, v64, s[52:55], 0 offen offset:64
    buffer_load_short_d16_hi v62, v64, s[52:55], 0 offen offset:80
    buffer_load_short_d16 v59, v64, s[52:55], 0 offen offset:96
    buffer_load_short_d16_hi v63, v64, s[52:55], 0 offen offset:112
    s_mov_b32 exec_lo, 0x000f0000
    s_mov_b32 exec_hi, 0x00f00000
    buffer_load_short_d16 v56, v65, s[56:59], 0 offen offset:0
    buffer_load_short_d16_hi v60, v65, s[56:59], 0 offen offset:8
    buffer_load_short_d16 v57, v65, s[56:59], 0 offen offset:16
    buffer_load_short_d16_hi v61, v65, s[56:59], 0 offen offset:24
    buffer_load_short_d16 v58, v65, s[56:59], 0 offen offset:32
    buffer_load_short_d16_hi v62, v65, s[56:59], 0 offen offset:40
    buffer_load_short_d16 v59, v65, s[56:59], 0 offen offset:48
    buffer_load_short_d16_hi v63, v65, s[56:59], 0 offen offset:56
    s_mov_b64 exec, -1
    v_add_lshl_u32 v66, v126, s22, 3
    v_lshrrev_b32 v66, 2, v66
    v_mov_b32 v74, 0
    v_mov_b32 v82, 0
    v_mov_b32 v90, 0
    s_lshr_b32 s28, s24, 2
    s_add_u32 s27, s28, 3072
    buffer_load_short_d16_hi v74, v66, s[60:63], s27 offen
    s_add_u32 s27, s28, 4096
    buffer_load_short_d16_hi v82, v66, s[60:63], s27 offen
    s_add_u32 s27, s28, 5120
    buffer_load_short_d16_hi v90, v66, s[60:63], s27 offen
    ds_write_b128 v112, v[108:111] offset:8192
    ds_write_b128 v112, v[108:111] offset:16384
    ds_write_b128 v112, v[108:111] offset:24576
    ds_write_b128 v112, v[108:111] offset:32768
    ds_write_b128 v112, v[108:111] offset:40960
    ds_write_b128 v112, v[108:111] offset:49152
    ds_write_b128 v112, v[108:111] offset:57344
    v_add_u32 v112, 65536, v112
    ds_write_b128 v112, v[108:111] offset:0
    ds_write_b128 v112, v[108:111] offset:8192
    ds_write_b128 v112, v[108:111] offset:16384
    ds_write_b128 v112, v[108:111] offset:24576
    v_cmp_gt_u32 vcc, 256, v126
    s_mov_b64 exec, vcc
    ds_write_b128 v112, v[108:111] offset:32768
    s_mov_b64 exec, -1
    s_lshr_b32 s28, s21, 7
    s_mul_i32 s27, s28, 3276800
    s_add_u32 s27, s27, 81788928
    s_add_u32 s8, s4, s27
    s_addc_u32 s9, s5, 0
    s_or_b32 s9, s9, 0x80000
    s_mov_b32 s10, 400000
    s_mov_b32 s11, 0x00020000
    s_mov_b32 s30, 0xfff8
    s_mov_b32 s44, 0x4b008000
    s_mov_b32 s45, 0x4b008000
    s_mov_b32 s46, 0x7fff8000
    s_mov_b32 s47, 0x7fff7fff
    s_mov_b32 s48, 0x05040100
    s_lshl_b32 s27, s20, 2
    v_mov_b32 v3, s27
    v_mov_b32 v6, 0xc357ffff
    v_mov_b32 v19, 0
    v_mov_b32 v7, 0xc357ffff
    v_mov_b32 v20, 0
    v_mov_b32 v8, 0xc357ffff
    v_mov_b32 v21, 0
    v_mov_b32 v9, 0xc357ffff
    v_mov_b32 v22, 0
    v_mov_b32 v10, 0xc357ffff
    v_mov_b32 v23, 0
    v_mov_b32 v11, 0xc357ffff
    v_mov_b32 v24, 0
    v_mov_b32 v12, 0xc357ffff
    v_mov_b32 v25, 0
    v_mov_b32 v13, 0xc357ffff
    v_mov_b32 v26, 0
    v_mov_b32 v14, 0xc357ffff
    v_mov_b32 v27, 0
    v_mov_b32 v15, 0xc357ffff
    v_mov_b32 v28, 0
    v_mov_b32 v16, 0xc357ffff
    v_mov_b32 v29, 0
    v_mov_b32 v17, 0xc357ffff
    v_mov_b32 v30, 0
    v_mov_b32 v18, 0xc357ffff
    v_mov_b32 v31, 0
    v_mov_b32 v120, 0
    v_mov_b32 v121, 0
    v_mov_b32 v122, 0
    v_mov_b32 v123, 0
    s_mov_b32 s26, 0
    v_lshlrev_b32 v67, 4, v1
    v_add_u32 v67, 155968, v67
    s_waitcnt vmcnt(0)
    v_or_b32 v98, v56, v60
    v_or_b32 v99, v57, v61
    v_or_b32 v100, v58, v62
    v_or_b32 v101, v59, v63
    ds_write_b128 v67, v[98:101]
    v_max3_u32 v104, v32, v34, v36
    v_add_f32 v105, v33, v35
    v_add_f32 v106, v37, v39
    v_max_u32 v104, v104, v38
    v_add_f32 v105, v105, v106
    s_nop 0
    v_max_u32_dpp v104, v104, v104 row_shr:1 row_mask:0xf bank_mask:0xf bound_ctrl:0
    s_nop 1
    v_max_u32_dpp v104, v104, v104 row_shr:2 row_mask:0xf bank_mask:0xf bound_ctrl:0
    s_nop 1
    v_max_u32_dpp v104, v104, v104 row_shr:4 row_mask:0xf bank_mask:0xf bound_ctrl:0
    s_nop 1
    v_max_u32_dpp v104, v104, v104 row_shr:8 row_mask:0xf bank_mask:0xf bound_ctrl:0
    s_nop 1
    v_max_u32_dpp v104, v104, v104 row_bcast:15 row_mask:0xa bank_mask:0xf
    s_nop 1
    v_max_u32_dpp v104, v104, v104 row_bcast:31 row_mask:0xc bank_mask:0xf
    v_add_f32_dpp v105, v105, v105 row_shr:1 row_mask:0xf bank_mask:0xf bound_ctrl:0
    s_nop 1
    v_add_f32_dpp v105, v105, v105 row_shr:2 row_mask:0xf bank_mask:0xf bound_ctrl:0
    s_nop 1
    v_add_f32_dpp v105, v105, v105 row_shr:4 row_mask:0xf bank_mask:0xf bound_ctrl:0
    s_nop 1
    v_add_f32_dpp v105, v105, v105 row_shr:8 row_mask:0xf bank_mask:0xf bound_ctrl:0
    s_nop 1
    v_add_f32_dpp v105, v105, v105 row_bcast:15 row_mask:0xa bank_mask:0xf
    s_nop 1
    v_add_f32_dpp v105, v105, v105 row_bcast:31 row_mask:0xc bank_mask:0xf
    v_rcp_f32 v108, v104
    v_mul_f32 v106, 0x47c35000, v104
    v_readlane_b32 s49, v104, 63
    v_cmp_nle_f32 vcc, v106, v105
    v_mul_f32 v108, 0x45800000, v108
    s_lshr_b32 s27, vcc_hi, 16
    s_and_b32 s27, s27, 0x8000
    v_mov_b32 v124, s27
    v_min_f32 v108, 0x71800000, v108
    v_rcp_f32 v109, v108
    v_add_f32 v110, v108, v108
    v_readlane_b32 s40, v108, 63
    v_readlane_b32 s41, v110, 63
    s_lshl_b64 exec, 1, 63
    ds_write_b32 v2, v109 offset:2056
    s_mov_b64 exec, -1
    s_xor_b32 s42, s40, 0x80000000
    v_mov_b32 v125, 4
    s_mov_b64 exec, 1
    ds_add_u32 v2, v125 offset:2080
    s_mov_b64 exec, -1
    v_readlane_b32 s68, v109, 63
    v_readlane_b32 s69, v109, 63
    s_waitcnt lgkmcnt(0)
    s_mov_b32 s52, 0x80000000
    s_mov_b32 s53, 0xbf0aa327
    s_mov_b32 s54, 0xbf8aa327
    s_mov_b32 s55, 0xbfcff4ba
    s_mov_b32 s56, 0xc00aa327
    s_mov_b32 s57, 0xc02dc57c
    s_mov_b32 s58, 0xc04ff4ba
    s_mov_b32 s59, 0xc0731710
    s_lshl_b32 s72, s88, 16
    s_and_b32 s73, s88, s31
    s_lshl_b32 s74, s89, 16
    s_and_b32 s75, s89, s31
    s_lshl_b32 s76, s90, 16
    s_and_b32 s77, s90, s31
    s_lshl_b32 s78, s91, 16
    s_and_b32 s79, s91, s31
    s_lshl_b32 s80, s92, 16
    s_and_b32 s81, s92, s31
    s_lshl_b32 s82, s93, 16
    s_and_b32 s83, s93, s31
    s_lshl_b32 s84, s94, 16
    s_and_b32 s85, s94, s31
    s_lshl_b32 s86, s95, 16
    s_and_b32 s87, s95, s31
    v_mul_f32 v64, 0x40731710, v74
    v_pk_add_f32 v[74:75], v[64:65], s[52:53] op_sel_hi:[0,1]
    v_pk_add_f32 v[76:77], v[64:65], s[54:55] op_sel_hi:[0,1]
    v_pk_add_f32 v[78:79], v[64:65], s[56:57] op_sel_hi:[0,1]
    v_pk_add_f32 v[80:81], v[64:65], s[58:59] op_sel_hi:[0,1]
    v_pk_mul_f32 v[74:75], v[74:75], v[74:75]
    v_pk_mul_f32 v[76:77], v[76:77], v[76:77]
    v_pk_mul_f32 v[78:79], v[78:79], v[78:79]
    v_pk_mul_f32 v[80:81], v[80:81], v[80:81]
    v_exp_f32 v74, -v74
    v_exp_f32 v75, -v75
    v_exp_f32 v76, -v76
    v_exp_f32 v77, -v77
    v_exp_f32 v78, -v78
    v_exp_f32 v79, -v79
    v_exp_f32 v80, -v80
    v_exp_f32 v81, -v81
    v_cvt_pk_bf16_f32 v60, v74, v75
    v_cvt_pk_bf16_f32 v61, v76, v77
    v_cvt_pk_bf16_f32 v62, v78, v79
    v_cvt_pk_bf16_f32 v63, v80, v81
    s_nop 1
    v_mfma_f32_32x32x16_bf16 v[32:47], v[98:101], v[60:63], 0
    v_mul_f32 v64, 0x40731710, v82
    v_pk_add_f32 v[82:83], v[64:65], s[52:53] op_sel_hi:[0,1]
    v_pk_add_f32 v[84:85], v[64:65], s[54:55] op_sel_hi:[0,1]
    v_pk_add_f32 v[86:87], v[64:65], s[56:57] op_sel_hi:[0,1]
    v_pk_add_f32 v[88:89], v[64:65], s[58:59] op_sel_hi:[0,1]
    v_pk_mul_f32 v[82:83], v[82:83], v[82:83]
    v_pk_mul_f32 v[84:85], v[84:85], v[84:85]
    v_pk_mul_f32 v[86:87], v[86:87], v[86:87]
    v_pk_mul_f32 v[88:89], v[88:89], v[88:89]
    v_exp_f32 v82, -v82
    v_exp_f32 v83, -v83
    v_exp_f32 v84, -v84
    v_exp_f32 v85, -v85
    v_exp_f32 v86, -v86
    v_exp_f32 v87, -v87
    v_exp_f32 v88, -v88
    v_exp_f32 v89, -v89
    v_pk_mul_f32 v[74:75], v[32:33], s[68:69]
    v_pk_mul_f32 v[76:77], v[34:35], s[68:69]
    v_pk_mul_f32 v[78:79], v[36:37], s[68:69]
    v_pk_mul_f32 v[80:81], v[38:39], s[68:69]
    v_cvt_pk_bf16_f32 v60, v82, v83
    v_cvt_pk_bf16_f32 v61, v84, v85
    v_cvt_pk_bf16_f32 v62, v86, v87
    v_cvt_pk_bf16_f32 v63, v88, v89
    s_nop 1
    v_mfma_f32_32x32x16_bf16 v[32:47], v[98:101], v[60:63], 0
    v_mul_f32 v64, 0x40731710, v90
    v_pk_add_f32 v[90:91], v[64:65], s[52:53] op_sel_hi:[0,1]
    v_pk_add_f32 v[92:93], v[64:65], s[54:55] op_sel_hi:[0,1]
    v_pk_add_f32 v[94:95], v[64:65], s[56:57] op_sel_hi:[0,1]
    v_pk_add_f32 v[96:97], v[64:65], s[58:59] op_sel_hi:[0,1]
    v_pk_mul_f32 v[90:91], v[90:91], v[90:91]
    v_pk_mul_f32 v[92:93], v[92:93], v[92:93]
    v_pk_mul_f32 v[94:95], v[94:95], v[94:95]
    v_pk_mul_f32 v[96:97], v[96:97], v[96:97]
    v_exp_f32 v90, -v90
    v_exp_f32 v91, -v91
    v_exp_f32 v92, -v92
    v_exp_f32 v93, -v93
    v_exp_f32 v94, -v94
    v_exp_f32 v95, -v95
    v_exp_f32 v96, -v96
    v_exp_f32 v97, -v97
    v_pk_mul_f32 v[82:83], v[32:33], s[68:69]
    v_pk_mul_f32 v[84:85], v[34:35], s[68:69]
    v_pk_mul_f32 v[86:87], v[36:37], s[68:69]
    v_pk_mul_f32 v[88:89], v[38:39], s[68:69]
    v_cvt_pk_bf16_f32 v60, v90, v91
    v_cvt_pk_bf16_f32 v61, v92, v93
    v_cvt_pk_bf16_f32 v62, v94, v95
    v_cvt_pk_bf16_f32 v63, v96, v97
    s_nop 1
    v_mfma_f32_32x32x16_bf16 v[32:47], v[98:101], v[60:63], 0
    s_nop 11
    v_pk_mul_f32 v[90:91], v[32:33], s[68:69]
    v_pk_mul_f32 v[92:93], v[34:35], s[68:69]
    v_pk_mul_f32 v[94:95], v[36:37], s[68:69]
    v_pk_mul_f32 v[96:97], v[38:39], s[68:69]
    s_mov_b32 s37, 32
    s_setprio 1
K2_CLOOP:
    ds_read_b64 v[104:105], v2 offset:2080
    s_mov_b32 s32, s26
    s_add_u32 s37, s37, 32
    v_and_b32 v67, 0x7ffff, v17
    buffer_load_dwordx2 v[62:63], v67, s[8:11], 0 idxen
    v_mul_f32 v106, 0.15915494, v30
    v_fract_f32 v106, v106
    v_cos_f32 v106, v106
    v_and_b32_sdwa v67, v17, s30 dst_sel:DWORD dst_unused:UNUSED_PAD src0_sel:WORD_1 src1_sel:DWORD
    v_pk_mul_f32 v[64:65], v[106:107], s[40:41] op_sel_hi:[0,1]
    v_fma_f32 v66, v65, v106, s42
    s_cmp_le_u32 s32, 6
    s_cbranch_scc1 K2_ST1
    s_waitcnt vmcnt(5)
    v_lshlrev_b32 v108, 16, v32
    v_and_b32 v109, s31, v32
    v_lshlrev_b32 v110, 16, v33
    v_and_b32 v111, s31, v33
    v_pk_fma_f32 v[112:113], v[108:109], v[34:35], s[44:45] op_sel_hi:[1,0,1]
    v_pk_fma_f32 v[114:115], v[110:111], v[34:35], s[44:45] op_sel_hi:[1,0,1]
    v_pk_fma_f32 v[116:117], v[108:109], v[36:37], s[44:45] op_sel_hi:[1,0,1]
    v_pk_fma_f32 v[118:119], v[110:111], v[36:37], s[44:45] op_sel_hi:[1,0,1]
    v_perm_b32 v108, v113, v112, s48
    v_perm_b32 v109, v115, v114, s48
    v_perm_b32 v110, v117, v116, s48
    v_perm_b32 v111, v119, v118, s48
    v_lshl_add_u64 v[108:109], v[108:109], 0, s[46:47]
    v_lshl_add_u64 v[110:111], v[110:111], 0, s[46:47]
    s_waitcnt lgkmcnt(0)
    v_or3_b32 v124, v124, v120, v121
    v_or3_b32 v124, v124, v122, v123
    ds_add_rtn_u64 v[120:121], v37, v[108:109] offset:2176
    ds_add_rtn_u64 v[122:123], v37, v[110:111] offset:52224
K2_SB1:
K2_CPOLL:
    v_readfirstlane_b32 s27, v104
    v_readfirstlane_b32 s25, v105
    s_cmp_lt_u32 s27, s37
    s_cbranch_scc1 K2_CPOLL2
    s_and_b32 s50, s25, 1
    s_add_u32 s27, s25, 252
    s_lshr_b32 s27, s27, 8
    s_mul_i32 s28, s27, s20
    s_add_u32 s27, s28, s27
    s_lshr_b32 s28, s28, 3
    s_lshr_b32 s27, s27, 3
    s_sub_u32 s26, s27, s28
    s_lshl_b32 s28, s28, 7
    s_add_u32 s27, s28, 102400
    s_lshl_b32 s28, s28, 1
    s_add_u32 s28, s28, 118784
    v_lshl_add_u32 v4, v1, 2, s28
    v_lshl_add_u32 v5, v1, 1, s27
    s_cmp_lt_u32 s26, 12
    s_cbranch_scc1 K2_RSLOW
    ds_read_b32 v6, v4 offset:0
    ds_read_u16_d16_hi v19, v5 offset:0
    ds_read_b32 v7, v4 offset:256
    ds_read_u16_d16_hi v20, v5 offset:128
    ds_read_b32 v8, v4 offset:512
    ds_read_u16_d16_hi v21, v5 offset:256
    ds_read_b32 v9, v4 offset:768
    ds_read_u16_d16_hi v22, v5 offset:384
    ds_read_b32 v10, v4 offset:1024
    ds_read_u16_d16_hi v23, v5 offset:512
    ds_read_b32 v11, v4 offset:1280
    ds_read_u16_d16_hi v24, v5 offset:640
    ds_read_b32 v12, v4 offset:1536
    ds_read_u16_d16_hi v25, v5 offset:768
    ds_read_b32 v13, v4 offset:1792
    ds_read_u16_d16_hi v26, v5 offset:896
    ds_read_b32 v14, v4 offset:2048
    ds_read_u16_d16_hi v27, v5 offset:1024
    ds_read_b32 v15, v4 offset:2304
    ds_read_u16_d16_hi v28, v5 offset:1152
    ds_read_b32 v16, v4 offset:2560
    ds_read_u16_d16_hi v29, v5 offset:1280
    ds_read_b32 v17, v4 offset:2816
    ds_read_u16_d16_hi v30, v5 offset:1408
K2_RDONE:
    v_and_b32 v73, 0x7ffff, v18
    buffer_load_dwordx2 v[68:69], v73, s[8:11], 0 idxen
    v_mul_f32 v106, 0.15915494, v31
    v_fract_f32 v106, v106
    v_cos_f32 v106, v106
    v_and_b32_sdwa v73, v18, s30 dst_sel:DWORD dst_unused:UNUSED_PAD src0_sel:WORD_1 src1_sel:DWORD
    v_pk_mul_f32 v[70:71], v[106:107], s[40:41] op_sel_hi:[0,1]
    v_fma_f32 v72, v71, v106, s42
    s_cmp_le_u32 s32, 7
    s_cbranch_scc1 K2_ST2
    s_waitcnt vmcnt(5)
    v_lshlrev_b32 v108, 16, v38
    v_and_b32 v109, s31, v38
    v_lshlrev_b32 v110, 16, v39
    v_and_b32 v111, s31, v39
    v_pk_fma_f32 v[112:113], v[108:109], v[40:41], s[44:45] op_sel_hi:[1,0,1]
    v_pk_fma_f32 v[114:115], v[110:111], v[40:41], s[44:45] op_sel_hi:[1,0,1]
    v_pk_fma_f32 v[116:117], v[108:109], v[42:43], s[44:45] op_sel_hi:[1,0,1]
    v_pk_fma_f32 v[118:119], v[110:111], v[42:43], s[44:45] op_sel_hi:[1,0,1]
    v_perm_b32 v108, v113, v112, s48
    v_perm_b32 v109, v115, v114, s48
    v_perm_b32 v110, v117, v116, s48
    v_perm_b32 v111, v119, v118, s48
    v_lshl_add_u64 v[108:109], v[108:109], 0, s[46:47]
    v_lshl_add_u64 v[110:111], v[110:111], 0, s[46:47]
    s_waitcnt lgkmcnt(0)
    v_or3_b32 v124, v124, v120, v121
    v_or3_b32 v124, v124, v122, v123
    ds_add_rtn_u64 v[120:121], v43, v[108:109] offset:2176
    ds_add_rtn_u64 v[122:123], v43, v[110:111] offset:52224
K2_SB2:
    s_cmp_le_u32 s26, 12
    s_cbranch_scc1 K2_RD3
    ds_read_b32 v18, v4 offset:3072
    ds_read_u16_d16_hi v31, v5 offset:1536
    s_branch K2_RE3
K2_RD3:
    v_mov_b32 v18, 0xc357ffff
K2_RE3:
    s_cmp_gt_u32 s26, 13
    s_cbranch_scc1 K2_EXTRA
K2_NOEXTRA:
    s_mov_b64 exec, 1
    ds_add_u32 v2, v125 offset:2100
    s_mov_b64 exec, -1
    v_and_b32 v37, 0x7ffff, v6
    buffer_load_dwordx2 v[32:33], v37, s[8:11], 0 idxen
    v_mul_f32 v106, 0.15915494, v19
    v_fract_f32 v106, v106
    v_cos_f32 v106, v106
    v_and_b32_sdwa v37, v6, s30 dst_sel:DWORD dst_unused:UNUSED_PAD src0_sel:WORD_1 src1_sel:DWORD
    v_pk_mul_f32 v[34:35], v[106:107], s[40:41] op_sel_hi:[0,1]
    v_fma_f32 v36, v35, v106, s42
    s_cmp_le_u32 s32, 8
    s_cbranch_scc1 K2_SB4
    s_waitcnt vmcnt(5)
    v_lshlrev_b32 v108, 16, v44
    v_and_b32 v109, s31, v44
    v_lshlrev_b32 v110, 16, v45
    v_and_b32 v111, s31, v45
    v_pk_fma_f32 v[112:113], v[108:109], v[46:47], s[44:45] op_sel_hi:[1,0,1]
    v_pk_fma_f32 v[114:115], v[110:111], v[46:47], s[44:45] op_sel_hi:[1,0,1]
    v_pk_fma_f32 v[116:117], v[108:109], v[48:49], s[44:45] op_sel_hi:[1,0,1]
    v_pk_fma_f32 v[118:119], v[110:111], v[48:49], s[44:45] op_sel_hi:[1,0,1]
    v_perm_b32 v108, v113, v112, s48
    v_perm_b32 v109, v115, v114, s48
    v_perm_b32 v110, v117, v116, s48
    v_perm_b32 v111, v119, v118, s48
    v_lshl_add_u64 v[108:109], v[108:109], 0, s[46:47]
    v_lshl_add_u64 v[110:111], v[110:111], 0, s[46:47]
    s_waitcnt lgkmcnt(0)
    v_or3_b32 v124, v124, v120, v121
    v_or3_b32 v124, v124, v122, v123
    ds_add_rtn_u64 v[120:121], v49, v[108:109] offset:2176
    ds_add_rtn_u64 v[122:123], v49, v[110:111] offset:52224
K2_SB4:
    v_and_b32 v43, 0x7ffff, v7
    buffer_load_dwordx2 v[38:39], v43, s[8:11], 0 idxen
    v_mul_f32 v106, 0.15915494, v20
    v_fract_f32 v106, v106
    v_cos_f32 v106, v106
    v_and_b32_sdwa v43, v7, s30 dst_sel:DWORD dst_unused:UNUSED_PAD src0_sel:WORD_1 src1_sel:DWORD
    v_pk_mul_f32 v[40:41], v[106:107], s[40:41] op_sel_hi:[0,1]
    v_fma_f32 v42, v41, v106, s42
    s_cmp_le_u32 s32, 9
    s_cbranch_scc1 K2_SB5
    s_waitcnt vmcnt(5)
    v_lshlrev_b32 v108, 16, v50
    v_and_b32 v109, s31, v50
    v_lshlrev_b32 v110, 16, v51
    v_and_b32 v111, s31, v51
    v_pk_fma_f32 v[112:113], v[108:109], v[52:53], s[44:45] op_sel_hi:[1,0,1]
    v_pk_fma_f32 v[114:115], v[110:111], v[52:53], s[44:45] op_sel_hi:[1,0,1]
    v_pk_fma_f32 v[116:117], v[108:109], v[54:55], s[44:45] op_sel_hi:[1,0,1]
    v_pk_fma_f32 v[118:119], v[110:111], v[54:55], s[44:45] op_sel_hi:[1,0,1]
    v_perm_b32 v108, v113, v112, s48
    v_perm_b32 v109, v115, v114, s48
    v_perm_b32 v110, v117, v116, s48
    v_perm_b32 v111, v119, v118, s48
    v_lshl_add_u64 v[108:109], v[108:109], 0, s[46:47]
    v_lshl_add_u64 v[110:111], v[110:111], 0, s[46:47]
    s_waitcnt lgkmcnt(0)
    v_or3_b32 v124, v124, v120, v121
    v_or3_b32 v124, v124, v122, v123
    ds_add_rtn_u64 v[120:121], v55, v[108:109] offset:2176
    ds_add_rtn_u64 v[122:123], v55, v[110:111] offset:52224
K2_SB5:
    v_and_b32 v49, 0x7ffff, v8
    buffer_load_dwordx2 v[44:45], v49, s[8:11], 0 idxen
    v_mul_f32 v106, 0.15915494, v21
    v_fract_f32 v106, v106
    v_cos_f32 v106, v106
    v_and_b32_sdwa v49, v8, s30 dst_sel:DWORD dst_unused:UNUSED_PAD src0_sel:WORD_1 src1_sel:DWORD
    v_pk_mul_f32 v[46:47], v[106:107], s[40:41] op_sel_hi:[0,1]
    v_fma_f32 v48, v47, v106, s42
    s_cmp_le_u32 s32, 10
    s_cbranch_scc1 K2_SB6
    s_waitcnt vmcnt(5)
    v_lshlrev_b32 v108, 16, v56
    v_and_b32 v109, s31, v56
    v_lshlrev_b32 v110, 16, v57
    v_and_b32 v111, s31, v57
    v_pk_fma_f32 v[112:113], v[108:109], v[58:59], s[44:45] op_sel_hi:[1,0,1]
    v_pk_fma_f32 v[114:115], v[110:111], v[58:59], s[44:45] op_sel_hi:[1,0,1]
    v_pk_fma_f32 v[116:117], v[108:109], v[60:61], s[44:45] op_sel_hi:[1,0,1]
    v_pk_fma_f32 v[118:119], v[110:111], v[60:61], s[44:45] op_sel_hi:[1,0,1]
    v_perm_b32 v108, v113, v112, s48
    v_perm_b32 v109, v115, v114, s48
    v_perm_b32 v110, v117, v116, s48
    v_perm_b32 v111, v119, v118, s48
    v_lshl_add_u64 v[108:109], v[108:109], 0, s[46:47]
    v_lshl_add_u64 v[110:111], v[110:111], 0, s[46:47]
    s_waitcnt lgkmcnt(0)
    v_or3_b32 v124, v124, v120, v121
    v_or3_b32 v124, v124, v122, v123
    ds_add_rtn_u64 v[120:121], v61, v[108:109] offset:2176
    ds_add_rtn_u64 v[122:123], v61, v[110:111] offset:52224
K2_SB6:
    v_and_b32 v55, 0x7ffff, v9
    buffer_load_dwordx2 v[50:51], v55, s[8:11], 0 idxen
    v_mul_f32 v106, 0.15915494, v22
    v_fract_f32 v106, v106
    v_cos_f32 v106, v106
    v_and_b32_sdwa v55, v9, s30 dst_sel:DWORD dst_unused:UNUSED_PAD src0_sel:WORD_1 src1_sel:DWORD
    v_pk_mul_f32 v[52:53], v[106:107], s[40:41] op_sel_hi:[0,1]
    v_fma_f32 v54, v53, v106, s42
    s_cmp_le_u32 s32, 11
    s_cbranch_scc1 K2_SB7
    s_waitcnt vmcnt(5)
    v_lshlrev_b32 v108, 16, v62
    v_and_b32 v109, s31, v62
    v_lshlrev_b32 v110, 16, v63
    v_and_b32 v111, s31, v63
    v_pk_fma_f32 v[112:113], v[108:109], v[64:65], s[44:45] op_sel_hi:[1,0,1]
    v_pk_fma_f32 v[114:115], v[110:111], v[64:65], s[44:45] op_sel_hi:[1,0,1]
    v_pk_fma_f32 v[116:117], v[108:109], v[66:67], s[44:45] op_sel_hi:[1,0,1]
    v_pk_fma_f32 v[118:119], v[110:111], v[66:67], s[44:45] op_sel_hi:[1,0,1]
    v_perm_b32 v108, v113, v112, s48
    v_perm_b32 v109, v115, v114, s48
    v_perm_b32 v110, v117, v116, s48
    v_perm_b32 v111, v119, v118, s48
    v_lshl_add_u64 v[108:109], v[108:109], 0, s[46:47]
    v_lshl_add_u64 v[110:111], v[110:111], 0, s[46:47]
    s_waitcnt lgkmcnt(0)
    v_or3_b32 v124, v124, v120, v121
    v_or3_b32 v124, v124, v122, v123
    ds_add_rtn_u64 v[120:121], v67, v[108:109] offset:2176
    ds_add_rtn_u64 v[122:123], v67, v[110:111] offset:52224
K2_SB7:
    v_and_b32 v61, 0x7ffff, v10
    buffer_load_dwordx2 v[56:57], v61, s[8:11], 0 idxen
    v_mul_f32 v106, 0.15915494, v23
    v_fract_f32 v106, v106
    v_cos_f32 v106, v106
    v_and_b32_sdwa v61, v10, s30 dst_sel:DWORD dst_unused:UNUSED_PAD src0_sel:WORD_1 src1_sel:DWORD
    v_pk_mul_f32 v[58:59], v[106:107], s[40:41] op_sel_hi:[0,1]
    v_fma_f32 v60, v59, v106, s42
    s_cmp_le_u32 s32, 12
    s_cbranch_scc1 K2_SB8
    s_waitcnt vmcnt(5)
    v_lshlrev_b32 v108, 16, v68
    v_and_b32 v109, s31, v68
    v_lshlrev_b32 v110, 16, v69
    v_and_b32 v111, s31, v69
    v_pk_fma_f32 v[112:113], v[108:109], v[70:71], s[44:45] op_sel_hi:[1,0,1]
    v_pk_fma_f32 v[114:115], v[110:111], v[70:71], s[44:45] op_sel_hi:[1,0,1]
    v_pk_fma_f32 v[116:117], v[108:109], v[72:73], s[44:45] op_sel_hi:[1,0,1]
    v_pk_fma_f32 v[118:119], v[110:111], v[72:73], s[44:45] op_sel_hi:[1,0,1]
    v_perm_b32 v108, v113, v112, s48
    v_perm_b32 v109, v115, v114, s48
    v_perm_b32 v110, v117, v116, s48
    v_perm_b32 v111, v119, v118, s48
    v_lshl_add_u64 v[108:109], v[108:109], 0, s[46:47]
    v_lshl_add_u64 v[110:111], v[110:111], 0, s[46:47]
    s_waitcnt lgkmcnt(0)
    v_or3_b32 v124, v124, v120, v121
    v_or3_b32 v124, v124, v122, v123
    ds_add_rtn_u64 v[120:121], v73, v[108:109] offset:2176
    ds_add_rtn_u64 v[122:123], v73, v[110:111] offset:52224
K2_SB8:
    v_and_b32 v67, 0x7ffff, v11
    buffer_load_dwordx2 v[62:63], v67, s[8:11], 0 idxen
    v_mul_f32 v106, 0.15915494, v24
    v_fract_f32 v106, v106
    v_cos_f32 v106, v106
    v_and_b32_sdwa v67, v11, s30 dst_sel:DWORD dst_unused:UNUSED_PAD src0_sel:WORD_1 src1_sel:DWORD
    v_pk_mul_f32 v[64:65], v[106:107], s[40:41] op_sel_hi:[0,1]
    v_fma_f32 v66, v65, v106, s42
    s_cmp_le_u32 s26, 0
    s_cbranch_scc1 K2_SB9
    s_waitcnt vmcnt(5)
    v_lshlrev_b32 v108, 16, v32
    v_and_b32 v109, s31, v32
    v_lshlrev_b32 v110, 16, v33
    v_and_b32 v111, s31, v33
    v_pk_fma_f32 v[112:113], v[108:109], v[34:35], s[44:45] op_sel_hi:[1,0,1]
    v_pk_fma_f32 v[114:115], v[110:111], v[34:35], s[44:45] op_sel_hi:[1,0,1]
    v_pk_fma_f32 v[116:117], v[108:109], v[36:37], s[44:45] op_sel_hi:[1,0,1]
    v_pk_fma_f32 v[118:119], v[110:111], v[36:37], s[44:45] op_sel_hi:[1,0,1]
    v_perm_b32 v108, v113, v112, s48
    v_perm_b32 v109, v115, v114, s48
    v_perm_b32 v110, v117, v116, s48
    v_perm_b32 v111, v119, v118, s48
    v_lshl_add_u64 v[108:109], v[108:109], 0, s[46:47]
    v_lshl_add_u64 v[110:111], v[110:111], 0, s[46:47]
    s_waitcnt lgkmcnt(0)
    v_or3_b32 v124, v124, v120, v121
    v_or3_b32 v124, v124, v122, v123
    ds_add_rtn_u64 v[120:121], v37, v[108:109] offset:2176
    ds_add_rtn_u64 v[122:123], v37, v[110:111] offset:52224
K2_SB9:
    v_and_b32 v37, 0x7ffff, v12
    buffer_load_dwordx2 v[32:33], v37, s[8:11], 0 idxen
    v_mul_f32 v106, 0.15915494, v25
    v_fract_f32 v106, v106
    v_cos_f32 v106, v106
    v_and_b32_sdwa v37, v12, s30 dst_sel:DWORD dst_unused:UNUSED_PAD src0_sel:WORD_1 src1_sel:DWORD
    v_pk_mul_f32 v[34:35], v[106:107], s[40:41] op_sel_hi:[0,1]
    v_fma_f32 v36, v35, v106, s42
    s_cmp_le_u32 s26, 1
    s_cbranch_scc1 K2_SB10
    s_waitcnt vmcnt(5)
    v_lshlrev_b32 v108, 16, v38
    v_and_b32 v109, s31, v38
    v_lshlrev_b32 v110, 16, v39
    v_and_b32 v111, s31, v39
    v_pk_fma_f32 v[112:113], v[108:109], v[40:41], s[44:45] op_sel_hi:[1,0,1]
    v_pk_fma_f32 v[114:115], v[110:111], v[40:41], s[44:45] op_sel_hi:[1,0,1]
    v_pk_fma_f32 v[116:117], v[108:109], v[42:43], s[44:45] op_sel_hi:[1,0,1]
    v_pk_fma_f32 v[118:119], v[110:111], v[42:43], s[44:45] op_sel_hi:[1,0,1]
    v_perm_b32 v108, v113, v112, s48
    v_perm_b32 v109, v115, v114, s48
    v_perm_b32 v110, v117, v116, s48
    v_perm_b32 v111, v119, v118, s48
    v_lshl_add_u64 v[108:109], v[108:109], 0, s[46:47]
    v_lshl_add_u64 v[110:111], v[110:111], 0, s[46:47]
    s_waitcnt lgkmcnt(0)
    v_or3_b32 v124, v124, v120, v121
    v_or3_b32 v124, v124, v122, v123
    ds_add_rtn_u64 v[120:121], v43, v[108:109] offset:2176
    ds_add_rtn_u64 v[122:123], v43, v[110:111] offset:52224
K2_SB10:
    v_and_b32 v43, 0x7ffff, v13
    buffer_load_dwordx2 v[38:39], v43, s[8:11], 0 idxen
    v_mul_f32 v106, 0.15915494, v26
    v_fract_f32 v106, v106
    v_cos_f32 v106, v106
    v_and_b32_sdwa v43, v13, s30 dst_sel:DWORD dst_unused:UNUSED_PAD src0_sel:WORD_1 src1_sel:DWORD
    v_pk_mul_f32 v[40:41], v[106:107], s[40:41] op_sel_hi:[0,1]
    v_fma_f32 v42, v41, v106, s42
    s_cmp_le_u32 s26, 2
    s_cbranch_scc1 K2_SB11
    s_waitcnt vmcnt(5)
    v_lshlrev_b32 v108, 16, v44
    v_and_b32 v109, s31, v44
    v_lshlrev_b32 v110, 16, v45
    v_and_b32 v111, s31, v45
    v_pk_fma_f32 v[112:113], v[108:109], v[46:47], s[44:45] op_sel_hi:[1,0,1]
    v_pk_fma_f32 v[114:115], v[110:111], v[46:47], s[44:45] op_sel_hi:[1,0,1]
    v_pk_fma_f32 v[116:117], v[108:109], v[48:49], s[44:45] op_sel_hi:[1,0,1]
    v_pk_fma_f32 v[118:119], v[110:111], v[48:49], s[44:45] op_sel_hi:[1,0,1]
    v_perm_b32 v108, v113, v112, s48
    v_perm_b32 v109, v115, v114, s48
    v_perm_b32 v110, v117, v116, s48
    v_perm_b32 v111, v119, v118, s48
    v_lshl_add_u64 v[108:109], v[108:109], 0, s[46:47]
    v_lshl_add_u64 v[110:111], v[110:111], 0, s[46:47]
    s_waitcnt lgkmcnt(0)
    v_or3_b32 v124, v124, v120, v121
    v_or3_b32 v124, v124, v122, v123
    ds_add_rtn_u64 v[120:121], v49, v[108:109] offset:2176
    ds_add_rtn_u64 v[122:123], v49, v[110:111] offset:52224
K2_SB11:
    v_and_b32 v49, 0x7ffff, v14
    buffer_load_dwordx2 v[44:45], v49, s[8:11], 0 idxen
    v_mul_f32 v106, 0.15915494, v27
    v_fract_f32 v106, v106
    v_cos_f32 v106, v106
    v_and_b32_sdwa v49, v14, s30 dst_sel:DWORD dst_unused:UNUSED_PAD src0_sel:WORD_1 src1_sel:DWORD
    v_pk_mul_f32 v[46:47], v[106:107], s[40:41] op_sel_hi:[0,1]
    v_fma_f32 v48, v47, v106, s42
    s_cmp_le_u32 s26, 3
    s_cbranch_scc1 K2_SB12
    s_waitcnt vmcnt(5)
    v_lshlrev_b32 v108, 16, v50
    v_and_b32 v109, s31, v50
    v_lshlrev_b32 v110, 16, v51
    v_and_b32 v111, s31, v51
    v_pk_fma_f32 v[112:113], v[108:109], v[52:53], s[44:45] op_sel_hi:[1,0,1]
    v_pk_fma_f32 v[114:115], v[110:111], v[52:53], s[44:45] op_sel_hi:[1,0,1]
    v_pk_fma_f32 v[116:117], v[108:109], v[54:55], s[44:45] op_sel_hi:[1,0,1]
    v_pk_fma_f32 v[118:119], v[110:111], v[54:55], s[44:45] op_sel_hi:[1,0,1]
    v_perm_b32 v108, v113, v112, s48
    v_perm_b32 v109, v115, v114, s48
    v_perm_b32 v110, v117, v116, s48
    v_perm_b32 v111, v119, v118, s48
    v_lshl_add_u64 v[108:109], v[108:109], 0, s[46:47]
    v_lshl_add_u64 v[110:111], v[110:111], 0, s[46:47]
    s_waitcnt lgkmcnt(0)
    v_or3_b32 v124, v124, v120, v121
    v_or3_b32 v124, v124, v122, v123
    ds_add_rtn_u64 v[120:121], v55, v[108:109] offset:2176
    ds_add_rtn_u64 v[122:123], v55, v[110:111] offset:52224
K2_SB12:
    v_and_b32 v55, 0x7ffff, v15
    buffer_load_dwordx2 v[50:51], v55, s[8:11], 0 idxen
    v_mul_f32 v106, 0.15915494, v28
    v_fract_f32 v106, v106
    v_cos_f32 v106, v106
    v_and_b32_sdwa v55, v15, s30 dst_sel:DWORD dst_unused:UNUSED_PAD src0_sel:WORD_1 src1_sel:DWORD
    v_pk_mul_f32 v[52:53], v[106:107], s[40:41] op_sel_hi:[0,1]
    v_fma_f32 v54, v53, v106, s42
    s_cmp_le_u32 s26, 4
    s_cbranch_scc1 K2_SB13
    s_waitcnt vmcnt(5)
    v_lshlrev_b32 v108, 16, v56
    v_and_b32 v109, s31, v56
    v_lshlrev_b32 v110, 16, v57
    v_and_b32 v111, s31, v57
    v_pk_fma_f32 v[112:113], v[108:109], v[58:59], s[44:45] op_sel_hi:[1,0,1]
    v_pk_fma_f32 v[114:115], v[110:111], v[58:59], s[44:45] op_sel_hi:[1,0,1]
    v_pk_fma_f32 v[116:117], v[108:109], v[60:61], s[44:45] op_sel_hi:[1,0,1]
    v_pk_fma_f32 v[118:119], v[110:111], v[60:61], s[44:45] op_sel_hi:[1,0,1]
    v_perm_b32 v108, v113, v112, s48
    v_perm_b32 v109, v115, v114, s48
    v_perm_b32 v110, v117, v116, s48
    v_perm_b32 v111, v119, v118, s48
    v_lshl_add_u64 v[108:109], v[108:109], 0, s[46:47]
    v_lshl_add_u64 v[110:111], v[110:111], 0, s[46:47]
    s_waitcnt lgkmcnt(0)
    v_or3_b32 v124, v124, v120, v121
    v_or3_b32 v124, v124, v122, v123
    ds_add_rtn_u64 v[120:121], v61, v[108:109] offset:2176
    ds_add_rtn_u64 v[122:123], v61, v[110:111] offset:52224
K2_SB13:
    v_and_b32 v61, 0x7ffff, v16
    buffer_load_dwordx2 v[56:57], v61, s[8:11], 0 idxen
    v_mul_f32 v106, 0.15915494, v29
    v_fract_f32 v106, v106
    v_cos_f32 v106, v106
    v_and_b32_sdwa v61, v16, s30 dst_sel:DWORD dst_unused:UNUSED_PAD src0_sel:WORD_1 src1_sel:DWORD
    v_pk_mul_f32 v[58:59], v[106:107], s[40:41] op_sel_hi:[0,1]
    v_fma_f32 v60, v59, v106, s42
    s_cmp_le_u32 s26, 5
    s_cbranch_scc1 K2_SB14
    s_waitcnt vmcnt(5)
    v_lshlrev_b32 v108, 16, v62
    v_and_b32 v109, s31, v62
    v_lshlrev_b32 v110, 16, v63
    v_and_b32 v111, s31, v63
    v_pk_fma_f32 v[112:113], v[108:109], v[64:65], s[44:45] op_sel_hi:[1,0,1]
    v_pk_fma_f32 v[114:115], v[110:111], v[64:65], s[44:45] op_sel_hi:[1,0,1]
    v_pk_fma_f32 v[116:117], v[108:109], v[66:67], s[44:45] op_sel_hi:[1,0,1]
    v_pk_fma_f32 v[118:119], v[110:111], v[66:67], s[44:45] op_sel_hi:[1,0,1]
    v_perm_b32 v108, v113, v112, s48
    v_perm_b32 v109, v115, v114, s48
    v_perm_b32 v110, v117, v116, s48
    v_perm_b32 v111, v119, v118, s48
    v_lshl_add_u64 v[108:109], v[108:109], 0, s[46:47]
    v_lshl_add_u64 v[110:111], v[110:111], 0, s[46:47]
    s_waitcnt lgkmcnt(0)
    v_or3_b32 v124, v124, v120, v121
    v_or3_b32 v124, v124, v122, v123
    ds_add_rtn_u64 v[120:121], v67, v[108:109] offset:2176
    ds_add_rtn_u64 v[122:123], v67, v[110:111] offset:52224
K2_SB14:
    s_cmp_eq_u32 s50, 0
    s_cbranch_scc1 K2_CLOOP
    v_and_b32 v67, 0x7ffff, v17
    buffer_load_dwordx2 v[62:63], v67, s[8:11], 0 idxen
    v_mul_f32 v106, 0.15915494, v30
    v_fract_f32 v106, v106
    v_cos_f32 v106, v106
    v_and_b32_sdwa v67, v17, s30 dst_sel:DWORD dst_unused:UNUSED_PAD src0_sel:WORD_1 src1_sel:DWORD
    v_pk_mul_f32 v[64:65], v[106:107], s[40:41] op_sel_hi:[0,1]
    v_fma_f32 v66, v65, v106, s42
    s_cmp_le_u32 s26, 6
    s_cbranch_scc1 K2_SB15
    s_waitcnt vmcnt(5)
    v_lshlrev_b32 v108, 16, v32
    v_and_b32 v109, s31, v32
    v_lshlrev_b32 v110, 16, v33
    v_and_b32 v111, s31, v33
    v_pk_fma_f32 v[112:113], v[108:109], v[34:35], s[44:45] op_sel_hi:[1,0,1]
    v_pk_fma_f32 v[114:115], v[110:111], v[34:35], s[44:45] op_sel_hi:[1,0,1]
    v_pk_fma_f32 v[116:117], v[108:109], v[36:37], s[44:45] op_sel_hi:[1,0,1]
    v_pk_fma_f32 v[118:119], v[110:111], v[36:37], s[44:45] op_sel_hi:[1,0,1]
    v_perm_b32 v108, v113, v112, s48
    v_perm_b32 v109, v115, v114, s48
    v_perm_b32 v110, v117, v116, s48
    v_perm_b32 v111, v119, v118, s48
    v_lshl_add_u64 v[108:109], v[108:109], 0, s[46:47]
    v_lshl_add_u64 v[110:111], v[110:111], 0, s[46:47]
    s_waitcnt lgkmcnt(0)
    v_or3_b32 v124, v124, v120, v121
    v_or3_b32 v124, v124, v122, v123
    ds_add_rtn_u64 v[120:121], v37, v[108:109] offset:2176
    ds_add_rtn_u64 v[122:123], v37, v[110:111] offset:52224
K2_SB15:
    v_and_b32 v73, 0x7ffff, v18
    buffer_load_dwordx2 v[68:69], v73, s[8:11], 0 idxen
    v_mul_f32 v106, 0.15915494, v31
    v_fract_f32 v106, v106
    v_cos_f32 v106, v106
    v_and_b32_sdwa v73, v18, s30 dst_sel:DWORD dst_unused:UNUSED_PAD src0_sel:WORD_1 src1_sel:DWORD
    v_pk_mul_f32 v[70:71], v[106:107], s[40:41] op_sel_hi:[0,1]
    v_fma_f32 v72, v71, v106, s42
    s_cmp_le_u32 s26, 7
    s_cbranch_scc1 K2_SB16
    s_waitcnt vmcnt(5)
    v_lshlrev_b32 v108, 16, v38
    v_and_b32 v109, s31, v38
    v_lshlrev_b32 v110, 16, v39
    v_and_b32 v111, s31, v39
    v_pk_fma_f32 v[112:113], v[108:109], v[40:41], s[44:45] op_sel_hi:[1,0,1]
    v_pk_fma_f32 v[114:115], v[110:111], v[40:41], s[44:45] op_sel_hi:[1,0,1]
    v_pk_fma_f32 v[116:117], v[108:109], v[42:43], s[44:45] op_sel_hi:[1,0,1]
    v_pk_fma_f32 v[118:119], v[110:111], v[42:43], s[44:45] op_sel_hi:[1,0,1]
    v_perm_b32 v108, v113, v112, s48
    v_perm_b32 v109, v115, v114, s48
    v_perm_b32 v110, v117, v116, s48
    v_perm_b32 v111, v119, v118, s48
    v_lshl_add_u64 v[108:109], v[108:109], 0, s[46:47]
    v_lshl_add_u64 v[110:111], v[110:111], 0, s[46:47]
    s_waitcnt lgkmcnt(0)
    v_or3_b32 v124, v124, v120, v121
    v_or3_b32 v124, v124, v122, v123
    ds_add_rtn_u64 v[120:121], v43, v[108:109] offset:2176
    ds_add_rtn_u64 v[122:123], v43, v[110:111] offset:52224
K2_SB16:
    s_cmp_le_u32 s26, 8
    s_cbranch_scc1 K2_SB17
    s_waitcnt vmcnt(4)
    v_lshlrev_b32 v108, 16, v44
    v_and_b32 v109, s31, v44
    v_lshlrev_b32 v110, 16, v45
    v_and_b32 v111, s31, v45
    v_pk_fma_f32 v[112:113], v[108:109], v[46:47], s[44:45] op_sel_hi:[1,0,1]
    v_pk_fma_f32 v[114:115], v[110:111], v[46:47], s[44:45] op_sel_hi:[1,0,1]
    v_pk_fma_f32 v[116:117], v[108:109], v[48:49], s[44:45] op_sel_hi:[1,0,1]
    v_pk_fma_f32 v[118:119], v[110:111], v[48:49], s[44:45] op_sel_hi:[1,0,1]
    v_perm_b32 v108, v113, v112, s48
    v_perm_b32 v109, v115, v114, s48
    v_perm_b32 v110, v117, v116, s48
    v_perm_b32 v111, v119, v118, s48
    v_lshl_add_u64 v[108:109], v[108:109], 0, s[46:47]
    v_lshl_add_u64 v[110:111], v[110:111], 0, s[46:47]
    s_waitcnt lgkmcnt(0)
    v_or3_b32 v124, v124, v120, v121
    v_or3_b32 v124, v124, v122, v123
    ds_add_rtn_u64 v[120:121], v49, v[108:109] offset:2176
    ds_add_rtn_u64 v[122:123], v49, v[110:111] offset:52224
K2_SB17:
    s_cmp_le_u32 s26, 9
    s_cbranch_scc1 K2_SB18
    s_waitcnt vmcnt(3)
    v_lshlrev_b32 v108, 16, v50
    v_and_b32 v109, s31, v50
    v_lshlrev_b32 v110, 16, v51
    v_and_b32 v111, s31, v51
    v_pk_fma_f32 v[112:113], v[108:109], v[52:53], s[44:45] op_sel_hi:[1,0,1]
    v_pk_fma_f32 v[114:115], v[110:111], v[52:53], s[44:45] op_sel_hi:[1,0,1]
    v_pk_fma_f32 v[116:117], v[108:109], v[54:55], s[44:45] op_sel_hi:[1,0,1]
    v_pk_fma_f32 v[118:119], v[110:111], v[54:55], s[44:45] op_sel_hi:[1,0,1]
    v_perm_b32 v108, v113, v112, s48
    v_perm_b32 v109, v115, v114, s48
    v_perm_b32 v110, v117, v116, s48
    v_perm_b32 v111, v119, v118, s48
    v_lshl_add_u64 v[108:109], v[108:109], 0, s[46:47]
    v_lshl_add_u64 v[110:111], v[110:111], 0, s[46:47]
    s_waitcnt lgkmcnt(0)
    v_or3_b32 v124, v124, v120, v121
    v_or3_b32 v124, v124, v122, v123
    ds_add_rtn_u64 v[120:121], v55, v[108:109] offset:2176
    ds_add_rtn_u64 v[122:123], v55, v[110:111] offset:52224
K2_SB18:
    s_cmp_le_u32 s26, 10
    s_cbranch_scc1 K2_SB19
    s_waitcnt vmcnt(2)
    v_lshlrev_b32 v108, 16, v56
    v_and_b32 v109, s31, v56
    v_lshlrev_b32 v110, 16, v57
    v_and_b32 v111, s31, v57
    v_pk_fma_f32 v[112:113], v[108:109], v[58:59], s[44:45] op_sel_hi:[1,0,1]
    v_pk_fma_f32 v[114:115], v[110:111], v[58:59], s[44:45] op_sel_hi:[1,0,1]
    v_pk_fma_f32 v[116:117], v[108:109], v[60:61], s[44:45] op_sel_hi:[1,0,1]
    v_pk_fma_f32 v[118:119], v[110:111], v[60:61], s[44:45] op_sel_hi:[1,0,1]
    v_perm_b32 v108, v113, v112, s48
    v_perm_b32 v109, v115, v114, s48
    v_perm_b32 v110, v117, v116, s48
    v_perm_b32 v111, v119, v118, s48
    v_lshl_add_u64 v[108:109], v[108:109], 0, s[46:47]
    v_lshl_add_u64 v[110:111], v[110:111], 0, s[46:47]
    s_waitcnt lgkmcnt(0)
    v_or3_b32 v124, v124, v120, v121
    v_or3_b32 v124, v124, v122, v123
    ds_add_rtn_u64 v[120:121], v61, v[108:109] offset:2176
    ds_add_rtn_u64 v[122:123], v61, v[110:111] offset:52224
K2_SB19:
    s_cmp_le_u32 s26, 11
    s_cbranch_scc1 K2_SB20
    s_waitcnt vmcnt(1)
    v_lshlrev_b32 v108, 16, v62
    v_and_b32 v109, s31, v62
    v_lshlrev_b32 v110, 16, v63
    v_and_b32 v111, s31, v63
    v_pk_fma_f32 v[112:113], v[108:109], v[64:65], s[44:45] op_sel_hi:[1,0,1]
    v_pk_fma_f32 v[114:115], v[110:111], v[64:65], s[44:45] op_sel_hi:[1,0,1]
    v_pk_fma_f32 v[116:117], v[108:109], v[66:67], s[44:45] op_sel_hi:[1,0,1]
    v_pk_fma_f32 v[118:119], v[110:111], v[66:67], s[44:45] op_sel_hi:[1,0,1]
    v_perm_b32 v108, v113, v112, s48
    v_perm_b32 v109, v115, v114, s48
    v_perm_b32 v110, v117, v116, s48
    v_perm_b32 v111, v119, v118, s48
    v_lshl_add_u64 v[108:109], v[108:109], 0, s[46:47]
    v_lshl_add_u64 v[110:111], v[110:111], 0, s[46:47]
    s_waitcnt lgkmcnt(0)
    v_or3_b32 v124, v124, v120, v121
    v_or3_b32 v124, v124, v122, v123
    ds_add_rtn_u64 v[120:121], v67, v[108:109] offset:2176
    ds_add_rtn_u64 v[122:123], v67, v[110:111] offset:52224
K2_SB20:
    s_cmp_le_u32 s26, 12
    s_cbranch_scc1 K2_SB21
    s_waitcnt vmcnt(0)
    v_lshlrev_b32 v108, 16, v68
    v_and_b32 v109, s31, v68
    v_lshlrev_b32 v110, 16, v69
    v_and_b32 v111, s31, v69
    v_pk_fma_f32 v[112:113], v[108:109], v[70:71], s[44:45] op_sel_hi:[1,0,1]
    v_pk_fma_f32 v[114:115], v[110:111], v[70:71], s[44:45] op_sel_hi:[1,0,1]
    v_pk_fma_f32 v[116:117], v[108:109], v[72:73], s[44:45] op_sel_hi:[1,0,1]
    v_pk_fma_f32 v[118:119], v[110:111], v[72:73], s[44:45] op_sel_hi:[1,0,1]
    v_perm_b32 v108, v113, v112, s48
    v_perm_b32 v109, v115, v114, s48
    v_perm_b32 v110, v117, v116, s48
    v_perm_b32 v111, v119, v118, s48
    v_lshl_add_u64 v[108:109], v[108:109], 0, s[46:47]
    v_lshl_add_u64 v[110:111], v[110:111], 0, s[46:47]
    s_waitcnt lgkmcnt(0)
    v_or3_b32 v124, v124, v120, v121
    v_or3_b32 v124, v124, v122, v123
    ds_add_rtn_u64 v[120:121], v73, v[108:109] offset:2176
    ds_add_rtn_u64 v[122:123], v73, v[110:111] offset:52224
K2_SB21:
    s_waitcnt lgkmcnt(0)
    v_or3_b32 v124, v124, v120, v121
    v_or3_b32 v124, v124, v122, v123
    v_and_b32 v124, 0x80008000, v124
    v_cmp_ne_u32 vcc, 0, v124
    v_mov_b32 v108, 0x7fffffff
    s_mov_b64 exec, vcc
    ds_or_b32 v2, v124 offset:2060
    s_mov_b64 exec, 1
    ds_write_b32 v3, v108 offset:2112
    s_mov_b64 exec, -1
    s_waitcnt vmcnt(0)
    v_add_lshl_u32 v68, v126, s22, 3
    v_add_lshl_u32 v70, v126, s23, 3
    v_lshlrev_b32 v72, 3, v126
    v_add_u32 v69, 50048, v68
    v_add_u32 v71, 50048, v70
    v_lshrrev_b32 v73, 2, v70
    v_mov_b32 v8, 0
    v_mov_b32 v16, 0
    v_mov_b32 v24, 0
    s_lshr_b32 s28, s24, 2
    s_add_u32 s27, s28, 3072
    buffer_load_short_d16_hi v8, v73, s[60:63], s27 offen
    s_add_u32 s27, s28, 4096
    buffer_load_short_d16_hi v16, v73, s[60:63], s27 offen
    s_add_u32 s27, s28, 5120
    buffer_load_short_d16_hi v24, v73, s[60:63], s27 offen
    s_add_u32 s27, s24, 12288
    buffer_load_dwordx2 v[38:39], v70, s[64:67], s27 offen
    s_add_u32 s27, s24, 16384
    buffer_load_dwordx2 v[40:41], v70, s[64:67], s27 offen
    s_add_u32 s27, s24, 20480
    buffer_load_dwordx2 v[42:43], v70, s[64:67], s27 offen
    s_cmp_ge_u32 s20, 4
    s_cbranch_scc1 K2_CP0
    s_setprio 0
    s_waitcnt vmcnt(3)
    v_mul_f32 v6, 0x40731710, v8
    v_pk_add_f32 v[8:9], v[6:7], s[52:53] op_sel_hi:[0,1]
    v_pk_add_f32 v[10:11], v[6:7], s[54:55] op_sel_hi:[0,1]
    v_pk_add_f32 v[12:13], v[6:7], s[56:57] op_sel_hi:[0,1]
    v_pk_add_f32 v[14:15], v[6:7], s[58:59] op_sel_hi:[0,1]
    v_pk_mul_f32 v[8:9], v[8:9], v[8:9]
    v_pk_mul_f32 v[10:11], v[10:11], v[10:11]
    v_pk_mul_f32 v[12:13], v[12:13], v[12:13]
    v_pk_mul_f32 v[14:15], v[14:15], v[14:15]
    v_exp_f32 v8, -v8
    v_exp_f32 v9, -v9
    v_exp_f32 v10, -v10
    v_exp_f32 v11, -v11
    v_exp_f32 v12, -v12
    v_exp_f32 v13, -v13
    v_exp_f32 v14, -v14
    v_exp_f32 v15, -v15
    v_cvt_pk_bf16_f32 v120, v8, v9
    v_cvt_pk_bf16_f32 v121, v10, v11
    v_cvt_pk_bf16_f32 v122, v12, v13
    v_cvt_pk_bf16_f32 v123, v14, v15
    s_nop 1
    v_mfma_f32_32x32x16_bf16 v[104:119], v[98:101], v[120:123], 0
    v_mul_f32 v6, 0x40731710, v16
    v_pk_add_f32 v[16:17], v[6:7], s[52:53] op_sel_hi:[0,1]
    v_pk_add_f32 v[18:19], v[6:7], s[54:55] op_sel_hi:[0,1]
    v_pk_add_f32 v[20:21], v[6:7], s[56:57] op_sel_hi:[0,1]
    v_pk_add_f32 v[22:23], v[6:7], s[58:59] op_sel_hi:[0,1]
    v_pk_mul_f32 v[16:17], v[16:17], v[16:17]
    v_pk_mul_f32 v[18:19], v[18:19], v[18:19]
    v_pk_mul_f32 v[20:21], v[20:21], v[20:21]
    v_pk_mul_f32 v[22:23], v[22:23], v[22:23]
    v_exp_f32 v16, -v16
    v_exp_f32 v17, -v17
    v_exp_f32 v18, -v18
    v_exp_f32 v19, -v19
    v_exp_f32 v20, -v20
    v_exp_f32 v21, -v21
    v_exp_f32 v22, -v22
    v_exp_f32 v23, -v23
    v_pk_mul_f32 v[8:9], v[104:105], s[68:69]
    v_pk_mul_f32 v[10:11], v[106:107], s[68:69]
    v_pk_mul_f32 v[12:13], v[108:109], s[68:69]
    v_pk_mul_f32 v[14:15], v[110:111], s[68:69]
    v_cvt_pk_bf16_f32 v32, v112, v113
    v_cvt_pk_bf16_f32 v33, v114, v115
    v_cvt_pk_bf16_f32 v120, v16, v17
    v_cvt_pk_bf16_f32 v121, v18, v19
    v_cvt_pk_bf16_f32 v122, v20, v21
    v_cvt_pk_bf16_f32 v123, v22, v23
    s_nop 1
    v_mfma_f32_32x32x16_bf16 v[104:119], v[98:101], v[120:123], 0
    v_mul_f32 v6, 0x40731710, v24
    v_pk_add_f32 v[24:25], v[6:7], s[52:53] op_sel_hi:[0,1]
    v_pk_add_f32 v[26:27], v[6:7], s[54:55] op_sel_hi:[0,1]
    v_pk_add_f32 v[28:29], v[6:7], s[56:57] op_sel_hi:[0,1]
    v_pk_add_f32 v[30:31], v[6:7], s[58:59] op_sel_hi:[0,1]
    v_pk_mul_f32 v[24:25], v[24:25], v[24:25]
    v_pk_mul_f32 v[26:27], v[26:27], v[26:27]
    v_pk_mul_f32 v[28:29], v[28:29], v[28:29]
    v_pk_mul_f32 v[30:31], v[30:31], v[30:31]
    v_exp_f32 v24, -v24
    v_exp_f32 v25, -v25
    v_exp_f32 v26, -v26
    v_exp_f32 v27, -v27
    v_exp_f32 v28, -v28
    v_exp_f32 v29, -v29
    v_exp_f32 v30, -v30
    v_exp_f32 v31, -v31
    v_pk_mul_f32 v[16:17], v[104:105], s[68:69]
    v_pk_mul_f32 v[18:19], v[106:107], s[68:69]
    v_pk_mul_f32 v[20:21], v[108:109], s[68:69]
    v_pk_mul_f32 v[22:23], v[110:111], s[68:69]
    v_cvt_pk_bf16_f32 v34, v112, v113
    v_cvt_pk_bf16_f32 v35, v114, v115
    v_cvt_pk_bf16_f32 v120, v24, v25
    v_cvt_pk_bf16_f32 v121, v26, v27
    v_cvt_pk_bf16_f32 v122, v28, v29
    v_cvt_pk_bf16_f32 v123, v30, v31
    s_nop 1
    v_mfma_f32_32x32x16_bf16 v[104:119], v[98:101], v[120:123], 0
    s_nop 11
    v_pk_mul_f32 v[24:25], v[104:105], s[68:69]
    v_pk_mul_f32 v[26:27], v[106:107], s[68:69]
    v_pk_mul_f32 v[28:29], v[108:109], s[68:69]
    v_pk_mul_f32 v[30:31], v[110:111], s[68:69]
    v_cvt_pk_bf16_f32 v36, v112, v113
    v_cvt_pk_bf16_f32 v37, v114, v115
K2_CP0:
    s_mov_b32 s25, 0x40004000
    s_setprio 3
    s_waitcnt lgkmcnt(0)
    s_barrier
    ds_read_b32 v124, v2 offset:2060
    ds_read_b64 v[44:45], v68 offset:14464
    ds_read_b64 v[46:47], v69 offset:14464
    ds_read_b64 v[48:49], v68 offset:18560
    ds_read_b64 v[50:51], v69 offset:18560
    ds_read_b64 v[52:53], v68 offset:22656
    ds_read_b64 v[54:55], v69 offset:22656
    ds_read_b64 v[56:57], v70 offset:14464
    ds_read_b64 v[58:59], v71 offset:14464
    ds_read_b64 v[60:61], v70 offset:18560
    ds_read_b64 v[62:63], v71 offset:18560
    ds_read_b64 v[64:65], v70 offset:22656
    ds_read_b64 v[66:67], v71 offset:22656
    s_waitcnt lgkmcnt(6)
    v_or3_b32 v124, v124, v44, v45
    v_or3_b32 v124, v124, v46, v47
    v_or3_b32 v124, v124, v48, v49
    v_or3_b32 v124, v124, v50, v51
    v_or3_b32 v124, v124, v52, v53
    v_or3_b32 v124, v124, v54, v55
    v_and_b32 v124, s33, v124
    v_cmp_eq_u32 vcc, 0, v124
    v_pk_sub_i16 v44, v44, s25
    v_pk_sub_i16 v45, v45, s25
    v_pk_sub_i16 v46, v46, s25
    v_pk_sub_i16 v47, v47, s25
    v_cvt_f32_i32_sdwa v120, sext(v44) dst_sel:DWORD dst_unused:UNUSED_PAD src0_sel:WORD_0
    v_cvt_f32_i32_sdwa v121, sext(v44) dst_sel:DWORD dst_unused:UNUSED_PAD src0_sel:WORD_1
    v_cvt_f32_i32_sdwa v122, sext(v45) dst_sel:DWORD dst_unused:UNUSED_PAD src0_sel:WORD_0
    v_cvt_f32_i32_sdwa v123, sext(v45) dst_sel:DWORD dst_unused:UNUSED_PAD src0_sel:WORD_1
    v_pk_mul_f32 v[120:121], v[74:75], v[120:121]
    v_pk_mul_f32 v[122:123], v[76:77], v[122:123]
    v_cvt_f32_i32_sdwa v74, sext(v46) dst_sel:DWORD dst_unused:UNUSED_PAD src0_sel:WORD_0
    v_cvt_f32_i32_sdwa v75, sext(v46) dst_sel:DWORD dst_unused:UNUSED_PAD src0_sel:WORD_1
    v_cvt_f32_i32_sdwa v76, sext(v47) dst_sel:DWORD dst_unused:UNUSED_PAD src0_sel:WORD_0
    v_cvt_f32_i32_sdwa v77, sext(v47) dst_sel:DWORD dst_unused:UNUSED_PAD src0_sel:WORD_1
    v_pk_fma_f32 v[120:121], v[78:79], v[74:75], v[120:121]
    v_pk_fma_f32 v[122:123], v[80:81], v[76:77], v[122:123]
    s_add_u32 s27, s36, 12288
    v_cvt_pk_bf16_f32 v44, v120, v121
    v_cvt_pk_bf16_f32 v45, v122, v123
    v_cndmask_b32 v44, -2, v44, vcc
    buffer_store_dwordx2 v[44:45], v72, s[4:7], s27 offen sc1
    v_pk_sub_i16 v48, v48, s25
    v_pk_sub_i16 v49, v49, s25
    v_pk_sub_i16 v50, v50, s25
    v_pk_sub_i16 v51, v51, s25
    v_cvt_f32_i32_sdwa v120, sext(v48) dst_sel:DWORD dst_unused:UNUSED_PAD src0_sel:WORD_0
    v_cvt_f32_i32_sdwa v121, sext(v48) dst_sel:DWORD dst_unused:UNUSED_PAD src0_sel:WORD_1
    v_cvt_f32_i32_sdwa v122, sext(v49) dst_sel:DWORD dst_unused:UNUSED_PAD src0_sel:WORD_0
    v_cvt_f32_i32_sdwa v123, sext(v49) dst_sel:DWORD dst_unused:UNUSED_PAD src0_sel:WORD_1
    v_pk_mul_f32 v[120:121], v[82:83], v[120:121]
    v_pk_mul_f32 v[122:123], v[84:85], v[122:123]
    v_cvt_f32_i32_sdwa v82, sext(v50) dst_sel:DWORD dst_unused:UNUSED_PAD src0_sel:WORD_0
    v_cvt_f32_i32_sdwa v83, sext(v50) dst_sel:DWORD dst_unused:UNUSED_PAD src0_sel:WORD_1
    v_cvt_f32_i32_sdwa v84, sext(v51) dst_sel:DWORD dst_unused:UNUSED_PAD src0_sel:WORD_0
    v_cvt_f32_i32_sdwa v85, sext(v51) dst_sel:DWORD dst_unused:UNUSED_PAD src0_sel:WORD_1
    v_pk_fma_f32 v[120:121], v[86:87], v[82:83], v[120:121]
    v_pk_fma_f32 v[122:123], v[88:89], v[84:85], v[122:123]
    s_add_u32 s27, s36, 16384
    v_cvt_pk_bf16_f32 v48, v120, v121
    v_cvt_pk_bf16_f32 v49, v122, v123
    buffer_store_dwordx2 v[48:49], v72, s[4:7], s27 offen sc1
    v_pk_sub_i16 v52, v52, s25
    v_pk_sub_i16 v53, v53, s25
    v_pk_sub_i16 v54, v54, s25
    v_pk_sub_i16 v55, v55, s25
    v_cvt_f32_i32_sdwa v120, sext(v52) dst_sel:DWORD dst_unused:UNUSED_PAD src0_sel:WORD_0
    v_cvt_f32_i32_sdwa v121, sext(v52) dst_sel:DWORD dst_unused:UNUSED_PAD src0_sel:WORD_1
    v_cvt_f32_i32_sdwa v122, sext(v53) dst_sel:DWORD dst_unused:UNUSED_PAD src0_sel:WORD_0
    v_cvt_f32_i32_sdwa v123, sext(v53) dst_sel:DWORD dst_unused:UNUSED_PAD src0_sel:WORD_1
    v_pk_mul_f32 v[120:121], v[90:91], v[120:121]
    v_pk_mul_f32 v[122:123], v[92:93], v[122:123]
    v_cvt_f32_i32_sdwa v90, sext(v54) dst_sel:DWORD dst_unused:UNUSED_PAD src0_sel:WORD_0
    v_cvt_f32_i32_sdwa v91, sext(v54) dst_sel:DWORD dst_unused:UNUSED_PAD src0_sel:WORD_1
    v_cvt_f32_i32_sdwa v92, sext(v55) dst_sel:DWORD dst_unused:UNUSED_PAD src0_sel:WORD_0
    v_cvt_f32_i32_sdwa v93, sext(v55) dst_sel:DWORD dst_unused:UNUSED_PAD src0_sel:WORD_1
    v_pk_fma_f32 v[120:121], v[94:95], v[90:91], v[120:121]
    v_pk_fma_f32 v[122:123], v[96:97], v[92:93], v[122:123]
    s_add_u32 s27, s36, 20480
    v_cvt_pk_bf16_f32 v52, v120, v121
    v_cvt_pk_bf16_f32 v53, v122, v123
    buffer_store_dwordx2 v[52:53], v72, s[4:7], s27 offen sc1
K2_NSC:
    s_setprio 2
    s_waitcnt vmcnt(3)
    s_cmp_lt_u32 s20, 4
    s_cbranch_scc1 K2_CP1
    v_mul_f32 v6, 0x40731710, v8
    v_pk_add_f32 v[8:9], v[6:7], s[52:53] op_sel_hi:[0,1]
    v_pk_add_f32 v[10:11], v[6:7], s[54:55] op_sel_hi:[0,1]
    v_pk_add_f32 v[12:13], v[6:7], s[56:57] op_sel_hi:[0,1]
    v_pk_add_f32 v[14:15], v[6:7], s[58:59] op_sel_hi:[0,1]
    v_pk_mul_f32 v[8:9], v[8:9], v[8:9]
    v_pk_mul_f32 v[10:11], v[10:11], v[10:11]
    v_pk_mul_f32 v[12:13], v[12:13], v[12:13]
    v_pk_mul_f32 v[14:15], v[14:15], v[14:15]
    v_exp_f32 v8, -v8
    v_exp_f32 v9, -v9
    v_exp_f32 v10, -v10
    v_exp_f32 v11, -v11
    v_exp_f32 v12, -v12
    v_exp_f32 v13, -v13
    v_exp_f32 v14, -v14
    v_exp_f32 v15, -v15
    v_cvt_pk_bf16_f32 v120, v8, v9
    v_cvt_pk_bf16_f32 v121, v10, v11
    v_cvt_pk_bf16_f32 v122, v12, v13
    v_cvt_pk_bf16_f32 v123, v14, v15
    s_nop 1
    v_mfma_f32_32x32x16_bf16 v[104:119], v[98:101], v[120:123], 0
    v_mul_f32 v6, 0x40731710, v16
    v_pk_add_f32 v[16:17], v[6:7], s[52:53] op_sel_hi:[0,1]
    v_pk_add_f32 v[18:19], v[6:7], s[54:55] op_sel_hi:[0,1]
    v_pk_add_f32 v[20:21], v[6:7], s[56:57] op_sel_hi:[0,1]
    v_pk_add_f32 v[22:23], v[6:7], s[58:59] op_sel_hi:[0,1]
    v_pk_mul_f32 v[16:17], v[16:17], v[16:17]
    v_pk_mul_f32 v[18:19], v[18:19], v[18:19]
    v_pk_mul_f32 v[20:21], v[20:21], v[20:21]
    v_pk_mul_f32 v[22:23], v[22:23], v[22:23]
    v_exp_f32 v16, -v16
    v_exp_f32 v17, -v17
    v_exp_f32 v18, -v18
    v_exp_f32 v19, -v19
    v_exp_f32 v20, -v20
    v_exp_f32 v21, -v21
    v_exp_f32 v22, -v22
    v_exp_f32 v23, -v23
    v_pk_mul_f32 v[8:9], v[104:105], s[68:69]
    v_pk_mul_f32 v[10:11], v[106:107], s[68:69]
    v_pk_mul_f32 v[12:13], v[108:109], s[68:69]
    v_pk_mul_f32 v[14:15], v[110:111], s[68:69]
    v_cvt_pk_bf16_f32 v32, v112, v113
    v_cvt_pk_bf16_f32 v33, v114, v115
    v_cvt_pk_bf16_f32 v120, v16, v17
    v_cvt_pk_bf16_f32 v121, v18, v19
    v_cvt_pk_bf16_f32 v122, v20, v21
    v_cvt_pk_bf16_f32 v123, v22, v23
    s_nop 1
    v_mfma_f32_32x32x16_bf16 v[104:119], v[98:101], v[120:123], 0
    v_mul_f32 v6, 0x40731710, v24
    v_pk_add_f32 v[24:25], v[6:7], s[52:53] op_sel_hi:[0,1]
    v_pk_add_f32 v[26:27], v[6:7], s[54:55] op_sel_hi:[0,1]
    v_pk_add_f32 v[28:29], v[6:7], s[56:57] op_sel_hi:[0,1]
    v_pk_add_f32 v[30:31], v[6:7], s[58:59] op_sel_hi:[0,1]
    v_pk_mul_f32 v[24:25], v[24:25], v[24:25]
    v_pk_mul_f32 v[26:27], v[26:27], v[26:27]
    v_pk_mul_f32 v[28:29], v[28:29], v[28:29]
    v_pk_mul_f32 v[30:31], v[30:31], v[30:31]
    v_exp_f32 v24, -v24
    v_exp_f32 v25, -v25
    v_exp_f32 v26, -v26
    v_exp_f32 v27, -v27
    v_exp_f32 v28, -v28
    v_exp_f32 v29, -v29
    v_exp_f32 v30, -v30
    v_exp_f32 v31, -v31
    v_pk_mul_f32 v[16:17], v[104:105], s[68:69]
    v_pk_mul_f32 v[18:19], v[106:107], s[68:69]
    v_pk_mul_f32 v[20:21], v[108:109], s[68:69]
    v_pk_mul_f32 v[22:23], v[110:111], s[68:69]
    v_cvt_pk_bf16_f32 v34, v112, v113
    v_cvt_pk_bf16_f32 v35, v114, v115
    v_cvt_pk_bf16_f32 v120, v24, v25
    v_cvt_pk_bf16_f32 v121, v26, v27
    v_cvt_pk_bf16_f32 v122, v28, v29
    v_cvt_pk_bf16_f32 v123, v30, v31
    s_nop 1
    v_mfma_f32_32x32x16_bf16 v[104:119], v[98:101], v[120:123], 0
    s_nop 11
    v_pk_mul_f32 v[24:25], v[104:105], s[68:69]
    v_pk_mul_f32 v[26:27], v[106:107], s[68:69]
    v_pk_mul_f32 v[28:29], v[108:109], s[68:69]
    v_pk_mul_f32 v[30:31], v[110:111], s[68:69]
    v_cvt_pk_bf16_f32 v36, v112, v113
    v_cvt_pk_bf16_f32 v37, v114, v115
K2_CP1:
    s_waitcnt lgkmcnt(0)
    v_or3_b32 v124, v124, v56, v57
    v_or3_b32 v124, v124, v58, v59
    v_or3_b32 v124, v124, v60, v61
    v_or3_b32 v124, v124, v62, v63
    v_or3_b32 v124, v124, v64, v65
    v_or3_b32 v124, v124, v66, v67
    v_and_b32 v124, s33, v124
    v_cmp_ne_u32 vcc, 0, v124
    s_cbranch_vccnz K2_TEC
    s_add_u32 s27, s38, 12288
    buffer_load_dwordx2 v[44:45], v72, s[4:7], s27 offen sc1
    s_add_u32 s27, s38, 16384
    buffer_load_dwordx2 v[48:49], v72, s[4:7], s27 offen sc1
    s_add_u32 s27, s38, 20480
    buffer_load_dwordx2 v[52:53], v72, s[4:7], s27 offen sc1
    s_mov_b32 exec_lo, 0x11111111
    s_mov_b32 exec_hi, 0x11111111
    s_pack_ll_b32_b16 s27, s88, s90
    v_mov_b32 v46, s27
    s_pack_ll_b32_b16 s27, s92, s94
    v_mov_b32 v47, s27
    s_mov_b32 exec_lo, 0x22222222
    s_mov_b32 exec_hi, 0x22222222
    s_pack_hh_b32_b16 s27, s88, s90
    v_mov_b32 v46, s27
    s_pack_hh_b32_b16 s27, s92, s94
    v_mov_b32 v47, s27
    s_mov_b32 exec_lo, 0x44444444
    s_mov_b32 exec_hi, 0x44444444
    s_pack_ll_b32_b16 s27, s89, s91
    v_mov_b32 v46, s27
    s_pack_ll_b32_b16 s27, s93, s95
    v_mov_b32 v47, s27
    s_mov_b32 exec_lo, 0x88888888
    s_mov_b32 exec_hi, 0x88888888
    s_pack_hh_b32_b16 s27, s89, s91
    v_mov_b32 v46, s27
    s_pack_hh_b32_b16 s27, s93, s95
    v_mov_b32 v47, s27
    s_mov_b64 exec, -1
    v_pk_sub_i16 v56, v56, s25
    v_pk_sub_i16 v57, v57, s25
    v_pk_sub_i16 v58, v58, s25
    v_pk_sub_i16 v59, v59, s25
    v_cvt_f32_i32_sdwa v120, sext(v56) dst_sel:DWORD dst_unused:UNUSED_PAD src0_sel:WORD_0
    v_cvt_f32_i32_sdwa v121, sext(v56) dst_sel:DWORD dst_unused:UNUSED_PAD src0_sel:WORD_1
    v_cvt_f32_i32_sdwa v122, sext(v57) dst_sel:DWORD dst_unused:UNUSED_PAD src0_sel:WORD_0
    v_cvt_f32_i32_sdwa v123, sext(v57) dst_sel:DWORD dst_unused:UNUSED_PAD src0_sel:WORD_1
    v_pk_mul_f32 v[120:121], v[8:9], v[120:121]
    v_pk_mul_f32 v[122:123], v[10:11], v[122:123]
    v_cvt_f32_i32_sdwa v8, sext(v58) dst_sel:DWORD dst_unused:UNUSED_PAD src0_sel:WORD_0
    v_cvt_f32_i32_sdwa v9, sext(v58) dst_sel:DWORD dst_unused:UNUSED_PAD src0_sel:WORD_1
    v_cvt_f32_i32_sdwa v10, sext(v59) dst_sel:DWORD dst_unused:UNUSED_PAD src0_sel:WORD_0
    v_cvt_f32_i32_sdwa v11, sext(v59) dst_sel:DWORD dst_unused:UNUSED_PAD src0_sel:WORD_1
    v_pk_fma_f32 v[120:121], v[12:13], v[8:9], v[120:121]
    v_pk_fma_f32 v[122:123], v[14:15], v[10:11], v[122:123]
    v_cvt_pk_bf16_f32 v8, v120, v121
    v_cvt_pk_bf16_f32 v9, v122, v123
    v_lshlrev_b32 v74, 16, v32
    v_and_b32 v75, s31, v32
    v_lshlrev_b32 v76, 16, v33
    v_and_b32 v77, s31, v33
    v_mfma_f32_4x4x4_16b_bf16 v[56:59], v[46:47], v[8:9], 0
    v_lshlrev_b32 v78, 16, v38
    v_and_b32 v79, s31, v38
    v_lshlrev_b32 v80, 16, v39
    v_and_b32 v81, s31, v39
    v_pk_sub_i16 v60, v60, s25
    v_pk_sub_i16 v61, v61, s25
    v_pk_sub_i16 v62, v62, s25
    v_pk_sub_i16 v63, v63, s25
    v_cvt_f32_i32_sdwa v120, sext(v60) dst_sel:DWORD dst_unused:UNUSED_PAD src0_sel:WORD_0
    v_cvt_f32_i32_sdwa v121, sext(v60) dst_sel:DWORD dst_unused:UNUSED_PAD src0_sel:WORD_1
    v_cvt_f32_i32_sdwa v122, sext(v61) dst_sel:DWORD dst_unused:UNUSED_PAD src0_sel:WORD_0
    v_cvt_f32_i32_sdwa v123, sext(v61) dst_sel:DWORD dst_unused:UNUSED_PAD src0_sel:WORD_1
    v_pk_mul_f32 v[120:121], v[16:17], v[120:121]
    v_pk_mul_f32 v[122:123], v[18:19], v[122:123]
    v_cvt_f32_i32_sdwa v16, sext(v62) dst_sel:DWORD dst_unused:UNUSED_PAD src0_sel:WORD_0
    v_cvt_f32_i32_sdwa v17, sext(v62) dst_sel:DWORD dst_unused:UNUSED_PAD src0_sel:WORD_1
    v_cvt_f32_i32_sdwa v18, sext(v63) dst_sel:DWORD dst_unused:UNUSED_PAD src0_sel:WORD_0
    v_cvt_f32_i32_sdwa v19, sext(v63) dst_sel:DWORD dst_unused:UNUSED_PAD src0_sel:WORD_1
    v_pk_fma_f32 v[120:121], v[20:21], v[16:17], v[120:121]
    v_pk_fma_f32 v[122:123], v[22:23], v[18:19], v[122:123]
    v_cvt_pk_bf16_f32 v16, v120, v121
    v_cvt_pk_bf16_f32 v17, v122, v123
    v_lshlrev_b32 v82, 16, v34
    v_and_b32 v83, s31, v34
    v_lshlrev_b32 v84, 16, v35
    v_and_b32 v85, s31, v35
    v_mfma_f32_4x4x4_16b_bf16 v[60:63], v[46:47], v[16:17], 0
    v_lshlrev_b32 v86, 16, v40
    v_and_b32 v87, s31, v40
    v_lshlrev_b32 v88, 16, v41
    v_and_b32 v89, s31, v41
    v_pk_sub_i16 v64, v64, s25
    v_pk_sub_i16 v65, v65, s25
    v_pk_sub_i16 v66, v66, s25
    v_pk_sub_i16 v67, v67, s25
    v_cvt_f32_i32_sdwa v120, sext(v64) dst_sel:DWORD dst_unused:UNUSED_PAD src0_sel:WORD_0
    v_cvt_f32_i32_sdwa v121, sext(v64) dst_sel:DWORD dst_unused:UNUSED_PAD src0_sel:WORD_1
    v_cvt_f32_i32_sdwa v122, sext(v65) dst_sel:DWORD dst_unused:UNUSED_PAD src0_sel:WORD_0
    v_cvt_f32_i32_sdwa v123, sext(v65) dst_sel:DWORD dst_unused:UNUSED_PAD src0_sel:WORD_1
    v_pk_mul_f32 v[120:121], v[24:25], v[120:121]
    v_pk_mul_f32 v[122:123], v[26:27], v[122:123]
    v_cvt_f32_i32_sdwa v24, sext(v66) dst_sel:DWORD dst_unused:UNUSED_PAD src0_sel:WORD_0
    v_cvt_f32_i32_sdwa v25, sext(v66) dst_sel:DWORD dst_unused:UNUSED_PAD src0_sel:WORD_1
    v_cvt_f32_i32_sdwa v26, sext(v67) dst_sel:DWORD dst_unused:UNUSED_PAD src0_sel:WORD_0
    v_cvt_f32_i32_sdwa v27, sext(v67) dst_sel:DWORD dst_unused:UNUSED_PAD src0_sel:WORD_1
    v_pk_fma_f32 v[120:121], v[28:29], v[24:25], v[120:121]
    v_pk_fma_f32 v[122:123], v[30:31], v[26:27], v[122:123]
    v_cvt_pk_bf16_f32 v24, v120, v121
    v_cvt_pk_bf16_f32 v25, v122, v123
    v_lshlrev_b32 v90, 16, v36
    v_and_b32 v91, s31, v36
    v_lshlrev_b32 v92, 16, v37
    v_and_b32 v93, s31, v37
    v_mfma_f32_4x4x4_16b_bf16 v[64:67], v[46:47], v[24:25], 0
    v_lshlrev_b32 v94, 16, v42
    v_and_b32 v95, s31, v42
    v_lshlrev_b32 v96, 16, v43
    v_and_b32 v97, s31, v43
K2_NOC:
    s_mov_b32 s28, 16384
    s_mov_b32 s29, 0xff800000
    s_branch K2_PXC
K2_PWC:
    s_add_u32 s27, s38, 12288
    buffer_load_dwordx2 v[44:45], v72, s[4:7], s27 offen sc1
    s_add_u32 s27, s38, 16384
    buffer_load_dwordx2 v[48:49], v72, s[4:7], s27 offen sc1
    s_add_u32 s27, s38, 20480
    buffer_load_dwordx2 v[52:53], v72, s[4:7], s27 offen sc1
K2_PXC:
    s_waitcnt vmcnt(0)
    v_max3_u32 v120, v44, v45, 0
    v_max3_u32 v120, v48, v49, v120
    v_max3_u32 v120, v52, v53, v120
    v_cmp_le_u32 vcc, s29, v120
    s_cbranch_vccnz K2_PRC
    v_mfma_f32_4x4x4_16b_bf16 v[56:59], v[46:47], v[44:45], v[56:59]
    v_mfma_f32_4x4x4_16b_bf16 v[60:63], v[46:47], v[48:49], v[60:63]
    v_mfma_f32_4x4x4_16b_bf16 v[64:67], v[46:47], v[52:53], v[64:67]
    s_add_u32 s27, s24, 12288
    s_nop 2
    v_pk_fma_f32 v[56:57], v[56:57], v[74:75], v[78:79]
    v_pk_fma_f32 v[58:59], v[58:59], v[76:77], v[80:81]
    v_cvt_pk_bf16_f32 v8, v56, v57
    v_cvt_pk_bf16_f32 v9, v58, v59
    buffer_store_dwordx2 v[8:9], v70, s[16:19], s27 offen
    s_add_u32 s27, s24, 16384
    v_pk_fma_f32 v[60:61], v[60:61], v[82:83], v[86:87]
    v_pk_fma_f32 v[62:63], v[62:63], v[84:85], v[88:89]
    v_cvt_pk_bf16_f32 v16, v60, v61
    v_cvt_pk_bf16_f32 v17, v62, v63
    buffer_store_dwordx2 v[16:17], v70, s[16:19], s27 offen
    s_add_u32 s27, s24, 20480
    v_pk_fma_f32 v[64:65], v[64:65], v[90:91], v[94:95]
    v_pk_fma_f32 v[66:67], v[66:67], v[92:93], v[96:97]
    v_cvt_pk_bf16_f32 v24, v64, v65
    v_cvt_pk_bf16_f32 v25, v66, v67
    buffer_store_dwordx2 v[24:25], v70, s[16:19], s27 offen
K2_TEC:
    v_cmp_ne_u32 vcc, 0, v124
    s_and_b64 exec, exec, vcc
    ds_or_b32 v2, v124 offset:2060
    s_mov_b64 exec, -1
    s_waitcnt lgkmcnt(0)
    s_barrier
    ds_read_b32 v124, v2 offset:2060
    s_waitcnt vmcnt(0) lgkmcnt(0)
    v_cmp_ne_u32 vcc, 0, v124
    s_cbranch_vccz K2_FIN
    s_and_b32 s27, s21, 127
    s_lshl_b32 s27, s27, 4
    v_mul_u32_u24 v22, 4224, v126
    v_add_u32 v22, s27, v22
    s_mov_b32 s27, 77594624
    buffer_load_dwordx4 v[32:35], v22, s[4:7], s27 offen offset:0
    buffer_load_dwordx4 v[36:39], v22, s[4:7], s27 offen offset:16
    buffer_load_dwordx4 v[40:43], v22, s[4:7], s27 offen offset:2048
    buffer_load_dwordx4 v[44:47], v22, s[4:7], s27 offen offset:2064
    v_mov_b32 v108, 0
    v_mov_b32 v109, 0
    v_mov_b32 v110, 0
    v_mov_b32 v111, 0
    v_lshlrev_b32 v112, 4, v126
    v_cmp_le_u32 vcc, 136, v126
    s_mov_b64 exec, vcc
    ds_write_b128 v112, v[108:111]
    s_mov_b64 exec, -1
    ds_write_b128 v112, v[108:111] offset:8192
    ds_write_b128 v112, v[108:111] offset:16384
    ds_write_b128 v112, v[108:111] offset:24576
    ds_write_b128 v112, v[108:111] offset:32768
    ds_write_b128 v112, v[108:111] offset:40960
    ds_write_b128 v112, v[108:111] offset:49152
    ds_write_b128 v112, v[108:111] offset:57344
    v_add_u32 v112, 65536, v112
    ds_write_b128 v112, v[108:111] offset:0
    ds_write_b128 v112, v[108:111] offset:8192
    ds_write_b128 v112, v[108:111] offset:16384
    ds_write_b128 v112, v[108:111] offset:24576
    v_cmp_gt_u32 vcc, 256, v126
    s_mov_b64 exec, vcc
    ds_write_b128 v112, v[108:111] offset:32768
    s_mov_b64 exec, -1
    s_mov_b32 s27, 150272
    v_mul_lo_u32 v24, v126, s27
    s_mov_b32 s28, 0x07060302
    v_mov_b32 v22, 0
    s_waitcnt vmcnt(0)
    v_perm_b32 v6, v36, v32, s48
    v_sub_u32_sdwa v23, v6, v6 dst_sel:DWORD dst_unused:UNUSED_PAD src0_sel:WORD_1 src1_sel:WORD_0
    v_add_u32 v22, v22, v23
    v_perm_b32 v7, v36, v32, s28
    v_sub_u32_sdwa v23, v7, v7 dst_sel:DWORD dst_unused:UNUSED_PAD src0_sel:WORD_1 src1_sel:WORD_0
    v_add_u32 v22, v22, v23
    v_perm_b32 v8, v37, v33, s48
    v_sub_u32_sdwa v23, v8, v8 dst_sel:DWORD dst_unused:UNUSED_PAD src0_sel:WORD_1 src1_sel:WORD_0
    v_add_u32 v22, v22, v23
    v_perm_b32 v9, v37, v33, s28
    v_sub_u32_sdwa v23, v9, v9 dst_sel:DWORD dst_unused:UNUSED_PAD src0_sel:WORD_1 src1_sel:WORD_0
    v_add_u32 v22, v22, v23
    v_perm_b32 v10, v38, v34, s48
    v_sub_u32_sdwa v23, v10, v10 dst_sel:DWORD dst_unused:UNUSED_PAD src0_sel:WORD_1 src1_sel:WORD_0
    v_add_u32 v22, v22, v23
    v_perm_b32 v11, v38, v34, s28
    v_sub_u32_sdwa v23, v11, v11 dst_sel:DWORD dst_unused:UNUSED_PAD src0_sel:WORD_1 src1_sel:WORD_0
    v_add_u32 v22, v22, v23
    v_perm_b32 v12, v39, v35, s48
    v_sub_u32_sdwa v23, v12, v12 dst_sel:DWORD dst_unused:UNUSED_PAD src0_sel:WORD_1 src1_sel:WORD_0
    v_add_u32 v22, v22, v23
    v_perm_b32 v13, v39, v35, s28
    v_sub_u32_sdwa v23, v13, v13 dst_sel:DWORD dst_unused:UNUSED_PAD src0_sel:WORD_1 src1_sel:WORD_0
    v_add_u32 v22, v22, v23
    v_perm_b32 v14, v44, v40, s48
    v_sub_u32_sdwa v23, v14, v14 dst_sel:DWORD dst_unused:UNUSED_PAD src0_sel:WORD_1 src1_sel:WORD_0
    v_add_u32 v22, v22, v23
    v_perm_b32 v15, v44, v40, s28
    v_sub_u32_sdwa v23, v15, v15 dst_sel:DWORD dst_unused:UNUSED_PAD src0_sel:WORD_1 src1_sel:WORD_0
    v_add_u32 v22, v22, v23
    v_perm_b32 v16, v45, v41, s48
    v_sub_u32_sdwa v23, v16, v16 dst_sel:DWORD dst_unused:UNUSED_PAD src0_sel:WORD_1 src1_sel:WORD_0
    v_add_u32 v22, v22, v23
    v_perm_b32 v17, v45, v41, s28
    v_sub_u32_sdwa v23, v17, v17 dst_sel:DWORD dst_unused:UNUSED_PAD src0_sel:WORD_1 src1_sel:WORD_0
    v_add_u32 v22, v22, v23
    v_perm_b32 v18, v46, v42, s48
    v_sub_u32_sdwa v23, v18, v18 dst_sel:DWORD dst_unused:UNUSED_PAD src0_sel:WORD_1 src1_sel:WORD_0
    v_add_u32 v22, v22, v23
    v_perm_b32 v19, v46, v42, s28
    v_sub_u32_sdwa v23, v19, v19 dst_sel:DWORD dst_unused:UNUSED_PAD src0_sel:WORD_1 src1_sel:WORD_0
    v_add_u32 v22, v22, v23
    v_perm_b32 v20, v47, v43, s48
    v_sub_u32_sdwa v23, v20, v20 dst_sel:DWORD dst_unused:UNUSED_PAD src0_sel:WORD_1 src1_sel:WORD_0
    v_add_u32 v22, v22, v23
    v_perm_b32 v21, v47, v43, s28
    v_sub_u32_sdwa v23, v21, v21 dst_sel:DWORD dst_unused:UNUSED_PAD src0_sel:WORD_1 src1_sel:WORD_0
    v_add_u32 v22, v22, v23
    ds_add_u32 v2, v22 offset:2048
    s_waitcnt lgkmcnt(0)
    s_barrier
    ds_read_b32 v108, v2 offset:2048
    s_lshr_b32 s28, s21, 7
    s_mul_i32 s28, s28, 3125
    s_sub_u32 s50, 3125, s28
    s_mov_b32 s22, 0
    s_waitcnt lgkmcnt(0)
    v_cvt_f32_u32 v108, v108
    v_mul_f32 v108, s49, v108
    v_rcp_f32 v108, v108
    s_nop 0
    v_mul_f32 v108, 0x4efc0000, v108
    v_min_f32 v108, 0x71800000, v108
    v_rcp_f32 v109, v108
    v_add_f32 v110, v108, v108
    v_readlane_b32 s40, v108, 63
    v_readlane_b32 s41, v110, 63
    s_lshl_b64 exec, 1, 63
    ds_write_b32 v2, v109 offset:2056
    s_mov_b64 exec, -1
    s_xor_b32 s42, s40, 0x80000000
K2_SJ:
    s_lshr_b32 s28, s22, 3
    s_mul_i32 s27, s28, 3276800
    s_add_u32 s27, s27, 81788928
    s_add_u32 s8, s4, s27
    s_addc_u32 s9, s5, 0
    s_or_b32 s9, s9, 0x80000
    v_and_b32 v22, 0xffff, v6
    v_lshrrev_b32 v23, 16, v6
    v_mov_b32 v6, v7
    v_mov_b32 v7, v8
    v_mov_b32 v8, v9
    v_mov_b32 v9, v10
    v_mov_b32 v10, v11
    v_mov_b32 v11, v12
    v_mov_b32 v12, v13
    v_mov_b32 v13, v14
    v_mov_b32 v14, v15
    v_mov_b32 v15, v16
    v_mov_b32 v16, v17
    v_mov_b32 v17, v18
    v_mov_b32 v18, v19
    v_mov_b32 v19, v20
    v_mov_b32 v20, v21
K2_SI:
    v_cmp_lt_u32 vcc, v22, v23
    s_cbranch_vccz K2_SN
    s_mov_b64 exec, vcc
    v_lshrrev_b32 v40, 1, v22
    v_mad_u32_u24 v40, v40, 12, v24
    buffer_load_dwordx3 v[26:28], v40, s[4:7], 0 offen
    v_and_b32 v40, 1, v22
    v_cmp_eq_u32 vcc, 1, v40
    v_add_u32 v22, 1, v22
    s_waitcnt vmcnt(0)
    v_cndmask_b32 v26, v26, v28, vcc
    v_lshlrev_b32 v28, 16, v27
    v_and_b32 v27, s31, v27
    v_cndmask_b32 v27, v28, v27, vcc
    v_and_b32 v42, 0x7ffff, v26
    buffer_load_dwordx2 v[40:41], v42, s[8:11], 0 idxen
    v_mul_f32 v106, 0.15915494, v27
    v_fract_f32 v106, v106
    v_cos_f32 v106, v106
    s_nop 0
    v_pk_mul_f32 v[30:31], v[106:107], s[40:41] op_sel_hi:[0,1]
    v_fma_f32 v32, v31, v106, s42
    v_lshrrev_b32 v26, 19, v26
    v_subrev_u32 v26, s50, v26
    v_cmp_gt_u32 vcc, 3125, v26
    v_lshlrev_b32 v26, 2, v26
    v_add_u32 v27, 50048, v26
    s_waitcnt vmcnt(0)
    v_lshlrev_b32 v108, 16, v40
    v_and_b32 v109, s31, v40
    v_lshlrev_b32 v110, 16, v41
    v_and_b32 v111, s31, v41
    v_pk_mul_f32 v[112:113], v[108:109], v[30:31] op_sel_hi:[1,0]
    v_pk_mul_f32 v[114:115], v[110:111], v[30:31] op_sel_hi:[1,0]
    v_pk_mul_f32 v[116:117], v[108:109], v[32:33] op_sel_hi:[1,0]
    v_pk_mul_f32 v[118:119], v[110:111], v[32:33] op_sel_hi:[1,0]
    v_cvt_rpi_i32_f32 v112, v112
    v_cvt_rpi_i32_f32 v113, v113
    v_cvt_rpi_i32_f32 v114, v114
    v_cvt_rpi_i32_f32 v115, v115
    v_cvt_rpi_i32_f32 v116, v116
    v_cvt_rpi_i32_f32 v117, v117
    v_cvt_rpi_i32_f32 v118, v118
    v_cvt_rpi_i32_f32 v119, v119
    s_mov_b64 exec, vcc
    ds_add_u32 v26, v112 offset:2176
    ds_add_u32 v26, v113 offset:14688
    ds_add_u32 v26, v114 offset:27200
    ds_add_u32 v26, v115 offset:39712
    ds_add_u32 v27, v116 offset:2176
    ds_add_u32 v27, v117 offset:14688
    ds_add_u32 v27, v118 offset:27200
    ds_add_u32 v27, v119 offset:39712
    s_mov_b64 exec, -1
    s_branch K2_SI
K2_SN:
    s_add_u32 s22, s22, 1
    s_cmp_lt_u32 s22, 16
    s_cbranch_scc1 K2_SJ
    s_waitcnt lgkmcnt(0)
    s_barrier
    s_branch K2_FIN
K2_PRC:
    v_cmp_eq_u32 vcc, -1, v120
    s_cbranch_vccz K2_PVC
    s_sub_u32 s28, s28, 1
    s_cbranch_scc0 K2_PWC
K2_PVC:
    v_mov_b32 v124, 0x8000
    s_branch K2_TEC
K2_ST1:
    s_waitcnt lgkmcnt(0)
    s_branch K2_SB1
K2_ST2:
    s_waitcnt lgkmcnt(0)
    s_branch K2_SB2
K2_CPOLL2:
    ds_read_b64 v[104:105], v2 offset:2080
    s_waitcnt lgkmcnt(0)
    s_branch K2_CPOLL
K2_RSLOW:
    s_cmp_le_u32 s26, 0
    s_cbranch_scc1 K2_RD23
    ds_read_b32 v6, v4 offset:0
    ds_read_u16_d16_hi v19, v5 offset:0
    s_branch K2_RE23
K2_RD23:
    v_mov_b32 v6, 0xc357ffff
K2_RE23:
    s_cmp_le_u32 s26, 1
    s_cbranch_scc1 K2_RD24
    ds_read_b32 v7, v4 offset:256
    ds_read_u16_d16_hi v20, v5 offset:128
    s_branch K2_RE24
K2_RD24:
    v_mov_b32 v7, 0xc357ffff
K2_RE24:
    s_cmp_le_u32 s26, 2
    s_cbranch_scc1 K2_RD25
    ds_read_b32 v8, v4 offset:512
    ds_read_u16_d16_hi v21, v5 offset:256
    s_branch K2_RE25
K2_RD25:
    v_mov_b32 v8, 0xc357ffff
K2_RE25:
    s_cmp_le_u32 s26, 3
    s_cbranch_scc1 K2_RD26
    ds_read_b32 v9, v4 offset:768
    ds_read_u16_d16_hi v22, v5 offset:384
    s_branch K2_RE26
K2_RD26:
    v_mov_b32 v9, 0xc357ffff
K2_RE26:
    s_cmp_le_u32 s26, 4
    s_cbranch_scc1 K2_RD27
    ds_read_b32 v10, v4 offset:1024
    ds_read_u16_d16_hi v23, v5 offset:512
    s_branch K2_RE27
K2_RD27:
    v_mov_b32 v10, 0xc357ffff
K2_RE27:
    s_cmp_le_u32 s26, 5
    s_cbranch_scc1 K2_RD28
    ds_read_b32 v11, v4 offset:1280
    ds_read_u16_d16_hi v24, v5 offset:640
    s_branch K2_RE28
K2_RD28:
    v_mov_b32 v11, 0xc357ffff
K2_RE28:
    s_cmp_le_u32 s26, 6
    s_cbranch_scc1 K2_RD29
    ds_read_b32 v12, v4 offset:1536
    ds_read_u16_d16_hi v25, v5 offset:768
    s_branch K2_RE29
K2_RD29:
    v_mov_b32 v12, 0xc357ffff
K2_RE29:
    s_cmp_le_u32 s26, 7
    s_cbranch_scc1 K2_RD30
    ds_read_b32 v13, v4 offset:1792
    ds_read_u16_d16_hi v26, v5 offset:896
    s_branch K2_RE30
K2_RD30:
    v_mov_b32 v13, 0xc357ffff
K2_RE30:
    s_cmp_le_u32 s26, 8
    s_cbranch_scc1 K2_RD31
    ds_read_b32 v14, v4 offset:2048
    ds_read_u16_d16_hi v27, v5 offset:1024
    s_branch K2_RE31
K2_RD31:
    v_mov_b32 v14, 0xc357ffff
K2_RE31:
    s_cmp_le_u32 s26, 9
    s_cbranch_scc1 K2_RD32
    ds_read_b32 v15, v4 offset:2304
    ds_read_u16_d16_hi v28, v5 offset:1152
    s_branch K2_RE32
K2_RD32:
    v_mov_b32 v15, 0xc357ffff
K2_RE32:
    s_cmp_le_u32 s26, 10
    s_cbranch_scc1 K2_RD33
    ds_read_b32 v16, v4 offset:2560
    ds_read_u16_d16_hi v29, v5 offset:1280
    s_branch K2_RE33
K2_RD33:
    v_mov_b32 v16, 0xc357ffff
K2_RE33:
    s_cmp_le_u32 s26, 11
    s_cbranch_scc1 K2_RD34
    ds_read_b32 v17, v4 offset:2816
    ds_read_u16_d16_hi v30, v5 offset:1408
    s_branch K2_RE34
K2_RD34:
    v_mov_b32 v17, 0xc357ffff
K2_RE34:
    s_branch K2_RDONE
K2_EXTRA:
    v_mov_b32 v105, 0
    ds_read_b32 v104, v4 offset:3328
    ds_read_u16_d16_hi v105, v5 offset:1664
    s_waitcnt lgkmcnt(0)
    v_and_b32 v37, 0x7ffff, v104
    buffer_load_dwordx2 v[32:33], v37, s[8:11], 0 idxen
    v_mul_f32 v106, 0.15915494, v105
    v_fract_f32 v106, v106
    v_cos_f32 v106, v106
    v_and_b32_sdwa v37, v104, s30 dst_sel:DWORD dst_unused:UNUSED_PAD src0_sel:WORD_1 src1_sel:DWORD
    v_pk_mul_f32 v[34:35], v[106:107], s[40:41] op_sel_hi:[0,1]
    v_fma_f32 v36, v35, v106, s42
    s_waitcnt vmcnt(0)
    v_lshlrev_b32 v108, 16, v32
    v_and_b32 v109, s31, v32
    v_lshlrev_b32 v110, 16, v33
    v_and_b32 v111, s31, v33
    v_pk_fma_f32 v[112:113], v[108:109], v[34:35], s[44:45] op_sel_hi:[1,0,1]
    v_pk_fma_f32 v[114:115], v[110:111], v[34:35], s[44:45] op_sel_hi:[1,0,1]
    v_pk_fma_f32 v[116:117], v[108:109], v[36:37], s[44:45] op_sel_hi:[1,0,1]
    v_pk_fma_f32 v[118:119], v[110:111], v[36:37], s[44:45] op_sel_hi:[1,0,1]
    v_perm_b32 v108, v113, v112, s48
    v_perm_b32 v109, v115, v114, s48
    v_perm_b32 v110, v117, v116, s48
    v_perm_b32 v111, v119, v118, s48
    v_lshl_add_u64 v[108:109], v[108:109], 0, s[46:47]
    v_lshl_add_u64 v[110:111], v[110:111], 0, s[46:47]
    s_waitcnt lgkmcnt(0)
    v_or3_b32 v124, v124, v120, v121
    v_or3_b32 v124, v124, v122, v123
    ds_add_rtn_u64 v[120:121], v37, v[108:109] offset:2176
    ds_add_rtn_u64 v[122:123], v37, v[110:111] offset:52224
    s_cmp_le_u32 s26, 14
    s_cbranch_scc1 K2_NOEXTRA
    v_mov_b32 v105, 0
    ds_read_b32 v104, v4 offset:3584
    ds_read_u16_d16_hi v105, v5 offset:1792
    s_waitcnt lgkmcnt(0)
    v_and_b32 v37, 0x7ffff, v104
    buffer_load_dwordx2 v[32:33], v37, s[8:11], 0 idxen
    v_mul_f32 v106, 0.15915494, v105
    v_fract_f32 v106, v106
    v_cos_f32 v106, v106
    v_and_b32_sdwa v37, v104, s30 dst_sel:DWORD dst_unused:UNUSED_PAD src0_sel:WORD_1 src1_sel:DWORD
    v_pk_mul_f32 v[34:35], v[106:107], s[40:41] op_sel_hi:[0,1]
    v_fma_f32 v36, v35, v106, s42
    s_waitcnt vmcnt(0)
    v_lshlrev_b32 v108, 16, v32
    v_and_b32 v109, s31, v32
    v_lshlrev_b32 v110, 16, v33
    v_and_b32 v111, s31, v33
    v_pk_fma_f32 v[112:113], v[108:109], v[34:35], s[44:45] op_sel_hi:[1,0,1]
    v_pk_fma_f32 v[114:115], v[110:111], v[34:35], s[44:45] op_sel_hi:[1,0,1]
    v_pk_fma_f32 v[116:117], v[108:109], v[36:37], s[44:45] op_sel_hi:[1,0,1]
    v_pk_fma_f32 v[118:119], v[110:111], v[36:37], s[44:45] op_sel_hi:[1,0,1]
    v_perm_b32 v108, v113, v112, s48
    v_perm_b32 v109, v115, v114, s48
    v_perm_b32 v110, v117, v116, s48
    v_perm_b32 v111, v119, v118, s48
    v_lshl_add_u64 v[108:109], v[108:109], 0, s[46:47]
    v_lshl_add_u64 v[110:111], v[110:111], 0, s[46:47]
    s_waitcnt lgkmcnt(0)
    v_or3_b32 v124, v124, v120, v121
    v_or3_b32 v124, v124, v122, v123
    ds_add_rtn_u64 v[120:121], v37, v[108:109] offset:2176
    ds_add_rtn_u64 v[122:123], v37, v[110:111] offset:52224
    s_cmp_le_u32 s26, 15
    s_cbranch_scc1 K2_NOEXTRA
    v_mov_b32 v105, 0
    ds_read_b32 v104, v4 offset:3840
    ds_read_u16_d16_hi v105, v5 offset:1920
    s_waitcnt lgkmcnt(0)
    v_and_b32 v37, 0x7ffff, v104
    buffer_load_dwordx2 v[32:33], v37, s[8:11], 0 idxen
    v_mul_f32 v106, 0.15915494, v105
    v_fract_f32 v106, v106
    v_cos_f32 v106, v106
    v_and_b32_sdwa v37, v104, s30 dst_sel:DWORD dst_unused:UNUSED_PAD src0_sel:WORD_1 src1_sel:DWORD
    v_pk_mul_f32 v[34:35], v[106:107], s[40:41] op_sel_hi:[0,1]
    v_fma_f32 v36, v35, v106, s42
    s_waitcnt vmcnt(0)
    v_lshlrev_b32 v108, 16, v32
    v_and_b32 v109, s31, v32
    v_lshlrev_b32 v110, 16, v33
    v_and_b32 v111, s31, v33
    v_pk_fma_f32 v[112:113], v[108:109], v[34:35], s[44:45] op_sel_hi:[1,0,1]
    v_pk_fma_f32 v[114:115], v[110:111], v[34:35], s[44:45] op_sel_hi:[1,0,1]
    v_pk_fma_f32 v[116:117], v[108:109], v[36:37], s[44:45] op_sel_hi:[1,0,1]
    v_pk_fma_f32 v[118:119], v[110:111], v[36:37], s[44:45] op_sel_hi:[1,0,1]
    v_perm_b32 v108, v113, v112, s48
    v_perm_b32 v109, v115, v114, s48
    v_perm_b32 v110, v117, v116, s48
    v_perm_b32 v111, v119, v118, s48
    v_lshl_add_u64 v[108:109], v[108:109], 0, s[46:47]
    v_lshl_add_u64 v[110:111], v[110:111], 0, s[46:47]
    s_waitcnt lgkmcnt(0)
    v_or3_b32 v124, v124, v120, v121
    v_or3_b32 v124, v124, v122, v123
    ds_add_rtn_u64 v[120:121], v37, v[108:109] offset:2176
    ds_add_rtn_u64 v[122:123], v37, v[110:111] offset:52224
    s_branch K2_NOEXTRA
K2_FIN:
K2_END:
    s_endpgm
.section .rodata,"a"
.p2align 6
.amdhsa_kernel gemnet_part_kernel
  .amdhsa_next_free_vgpr 128
  .amdhsa_next_free_sgpr 102
  .amdhsa_accum_offset 128
  .amdhsa_group_segment_fixed_size 0
  .amdhsa_kernarg_size 112
  .amdhsa_user_sgpr_count 2
  .amdhsa_user_sgpr_kernarg_segment_ptr 1
  .amdhsa_system_sgpr_workgroup_id_x 1
.end_amdhsa_kernel
.p2align 6
.amdhsa_kernel standalone__molecular_angular_gemnet__graph_kernel
  .amdhsa_next_free_vgpr 128
  .amdhsa_next_free_sgpr 102
  .amdhsa_accum_offset 128
  .amdhsa_group_segment_fixed_size 0
  .amdhsa_kernarg_size 112
  .amdhsa_user_sgpr_count 2
  .amdhsa_user_sgpr_kernarg_segment_ptr 1
  .amdhsa_system_sgpr_workgroup_id_x 1
.end_amdhsa_kernel
```
